```python
import torch

def _softmax(x, axis=-1):
    return torch.softmax(x, dim=axis)
def _gelu(x):
    return torch.nn.functional.gelu(x, approximate="tanh")
def _silu(x):
    return torch.nn.functional.silu(x)
def _sigmoid(x):
    return torch.sigmoid(x)
def _layernorm(x, axis=-1, eps=1e-5):
    m = x.mean(dim=axis, keepdim=True)
    v = x.var(dim=axis, keepdim=True, unbiased=False)
    return (x - m) / torch.sqrt(v + eps)
def _scatter_add(tgt, idx, src, axis=0):
    return tgt.clone().index_add_(axis, idx, src)
def _segment_sum(src, seg, n):
    out = torch.zeros((n,) + src.shape[1:], dtype=src.dtype)
    return out.index_add_(0, seg, src)
def _pad(x, pw):
    flat = tuple(v for pair in reversed(pw) for v in pair)
    return torch.nn.functional.pad(x, flat)

kernel_name = 'parallel_sum__ssm_conv_h3__dense_activation_silu__prompt'

def setup_inputs():

    _w = (lambda a: (lambda t: t.to(torch.bfloat16) if t.is_floating_point() else t)(torch.as_tensor(a)))
    def _A_setup():
        B, S, D = 1, 2048, 512
        ks = 4
        return {
            "q": _w((lambda *s: torch.randn(*s, dtype=torch.bfloat16) * 0.05)(B, S, D)),
            "k": _w((lambda *s: torch.randn(*s, dtype=torch.bfloat16) * 0.2)(B, S, D)),
            "v": _w((lambda *s: torch.randn(*s, dtype=torch.bfloat16) * 0.2)(B, S, D)),
            "shift_k": _w((lambda *s: torch.randn(*s, dtype=torch.bfloat16) * 0.2)(D, ks) * 0.5),
            "ssm_k": _w((lambda *s: torch.randn(*s, dtype=torch.bfloat16) * 0.8)(D, S) * (1.0 / S ** 0.5)),
            "ssm_D": _w((lambda *s: torch.randn(*s, dtype=torch.bfloat16) * 0.2)(D)),
        }
    _A_in = _A_setup()

    def _B_setup():
        B, S, D, F = 1, 2048, 512, 1792
        return {
            "x": _w((lambda *s: torch.randn(*s, dtype=torch.bfloat16) * 0.05)(B, S, D)),
            "w1": _w((lambda *s: torch.randn(*s, dtype=torch.bfloat16) * 0.8)(D, F) * (D ** -0.5)),
            "w2": _w((lambda *s: torch.randn(*s, dtype=torch.bfloat16) * 0.1)(F, D) * (F ** -0.5)),
        }
    _B_in = _B_setup()

    return {
        "A_q": _A_in["q"],
        "A_k": _A_in["k"],
        "A_v": _A_in["v"],
        "A_shift_k": _A_in["shift_k"],
        "A_ssm_k": _A_in["ssm_k"],
        "A_ssm_D": _A_in["ssm_D"],
        "B_x": _B_in["x"],
        "B_w1": _B_in["w1"],
        "B_w2": _B_in["w2"],
    }

def reference(A_q, A_k, A_v, A_shift_k, A_ssm_k, A_ssm_D, B_x, B_w1, B_w2):
    def _A_ref(q, k, v, shift_k, ssm_k, ssm_D):
        B, S, D = q.shape
        ks = shift_k.shape[-1]
        k_pad = _pad(k, ((0, 0), (ks - 1, 0), (0, 0)))
        k_shift = torch.zeros_like(k)
        for t in range(ks):
            k_shift = k_shift + k_pad[:, t:t + S, :] * shift_k[:, ks - 1 - t][None, None, :]
        kv = k_shift * v
        L = 2 * S
        kv_pad = _pad(kv, ((0, 0), (0, S), (0, 0)))
        kf_pad = _pad(ssm_k, ((0, 0), (0, S)))
        kv_f = (lambda x, axes=(-2,-1): torch.fft.rfft2(x.float(), dim=axes))(kv_pad[:, None, :, :], axes=(1, 2))
        kf_f = (lambda x, axes=(-2,-1): torch.fft.rfft2(x.float(), dim=axes))(kf_pad[:, None, :], axes=(1, 2))
        kf_f = (lambda x, *d: x.permute(*d))(kf_f, 1, 2, 0)
        y_f = kv_f * kf_f[None, :, :, :]
        y = (lambda x, s, axes=(-2,-1): torch.fft.irfft2(x, s=s, dim=axes).to(torch.bfloat16))(y_f, (1, L), axes=(1, 2))[:, 0, :S, :]
        y = y + kv * ssm_D[None, None, :]
        return q * y

    def _B_ref(x, w1, w2):
        h = torch.einsum("bsd,df->bsf", x, w1)
        h = _silu(h)
        out = torch.einsum("bsf,fd->bsd", h, w2)
        return out

    x = A_q
    xn = _layernorm(x, axis=-1)
    return x + _A_ref(xn, A_k, A_v, A_shift_k, A_ssm_k, A_ssm_D) + _B_ref(xn, B_w1, B_w2)
```

```asm
; @launch grid=(256,1,1) block=(256,1,1) lds=163840
.amdgcn_target "amdgcn-amd-amdhsa--gfx950"
.text
.globl parallel_sum__ssm_conv_h3__dense_activation_silu__prompt_kernel
.p2align 8
.type parallel_sum__ssm_conv_h3__dense_activation_silu__prompt_kernel,@function
parallel_sum__ssm_conv_h3__dense_activation_silu__prompt_kernel:
    s_cmp_ge_u32 s2, 256
    s_cbranch_scc1 L_end
    s_load_dwordx16 s[4:19], s[0:1], 0
    s_load_dwordx8 s[20:27], s[0:1], 64
    v_and_b32 v1, 63, v0
    v_lshrrev_b32 v2, 6, v0
    s_lshr_b32 s69, s2, 5
    v_readfirstlane_b32 s68, v2
    s_and_b32 s70, s2, 31
    s_getpc_b64 s[74:75]
L_pc0:
    s_lshl_b32 s64, s70, 2
    s_add_u32 s64, s64, s68
    s_lshl_b32 s64, s64, 8
    v_lshlrev_b32 v4, 2, v1
    v_add_u32 v4, s64, v4
    v_min_u32 v4, L_end-L_pc0, v4
    global_load_dword v5, v4, s[74:75]
    s_and_b32 s74, s69, 3
    s_lshl_b32 s74, s74, 2
    s_and_b32 s75, s70, 3
    s_add_u32 s71, s74, s75
    s_lshr_b32 s74, s69, 2
    s_lshl_b32 s74, s74, 3
    s_lshr_b32 s75, s70, 2
    s_add_u32 s72, s74, s75
    v_and_b32 v3, 7, v0
    v_lshlrev_b32 v3, 4, v3
    v_lshrrev_b32 v11, 3, v0
    v_lshlrev_b32 v11, 11, v11
    s_lshl_b32 s74, s70, 16
    s_lshl_b32 s75, s69, 7
    s_add_u32 s74, s74, s75
    s_sub_u32 s74, s74, 3072
    v_add3_u32 v6, v3, v11, s74
    v_add_u32 v7, 1024, v6
    v_add_u32 v8, 2048, v6
    v_add_u32 v9, 3072, v6
    v_add_u32 v10, 4096, v6
    v_lshlrev_b32 v3, 4, v1
    s_lshl_b32 s74, s69, 9
    s_waitcnt lgkmcnt(0)
    v_lshlrev_b32 v44, 7, v1
    v_add_u32 v44, 14680064, v44
    v_mov_b32 v45, 0
    s_or_b32 s67, s2, s68
    s_cmp_eq_u32 s67, 0
    s_cselect_b32 s67, -1, 0
    s_mov_b32 exec_lo, s67
    s_mov_b32 exec_hi, 0
    global_store_dword v44, v45, s[26:27] sc1
    s_mov_b64 exec, -1
    s_mov_b32 s32, s6
    s_and_b32 s33, s7, 0xffff
    s_mov_b32 s34, 2097152
    s_mov_b32 s35, 0x20000
    buffer_load_dwordx4 v[12:15], v6, s[32:35], 0 offen nt
    buffer_load_dwordx4 v[16:19], v7, s[32:35], 0 offen nt
    buffer_load_dwordx4 v[20:23], v8, s[32:35], 0 offen nt
    buffer_load_dwordx4 v[24:27], v9, s[32:35], 0 offen nt
    buffer_load_dwordx4 v[28:31], v10, s[32:35], 0 offen nt
    s_mov_b32 s36, s8
    s_and_b32 s37, s9, 0xffff
    s_mov_b32 s38, 2097152
    s_mov_b32 s39, 0x20000
    buffer_load_dwordx4 v[32:35], v9, s[36:39], 0 offen nt
    buffer_load_dwordx4 v[36:39], v10, s[36:39], 0 offen nt
    s_mov_b32 s56, s10
    s_and_b32 s57, s11, 0xffff
    s_mov_b32 s58, 4096
    s_mov_b32 s59, 0x20000
    buffer_load_dwordx4 v[40:43], v3, s[56:59], s74 offen
    s_mov_b32 s28, s4
    s_and_b32 s29, s5, 0xffff
    s_mov_b32 s30, 2097152
    s_mov_b32 s31, 0x20000
    s_lshl_b32 s74, s71, 4
    s_add_u32 s74, s74, s72
    s_lshl_b32 s74, s74, 2
    s_add_u32 s74, s74, s68
    s_lshl_b32 s101, s74, 1
    s_lshl_b32 s74, s74, 11
    buffer_load_dwordx4 v[44:47], v3, s[28:31], s74 offen
    buffer_load_dwordx4 v[48:51], v3, s[28:31], s74 offen offset:1024
    s_mov_b32 s44, s20
    s_and_b32 s45, s21, 0xffff
    s_mov_b32 s46, 1835008
    s_mov_b32 s47, 0x20000
    s_mov_b32 s40, s18
    s_and_b32 s41, s19, 0xffff
    s_mov_b32 s42, 1835008
    s_mov_b32 s43, 0x20000
    s_mov_b32 s48, s26
    s_and_b32 s49, s27, 0xffff
    s_mov_b32 s50, 14680064
    s_mov_b32 s51, 0x20000
    s_mov_b32 s60, s22
    s_and_b32 s61, s23, 0xffff
    s_mov_b32 s62, 2097152
    s_mov_b32 s63, 0x20000
    s_lshl_b32 s74, s69, 5
    s_add_u32 s74, s74, s70
    s_lshl_b32 s75, s74, 2
    s_load_dword s95, s[14:15], s75
    s_lshl_b32 s74, s74, 13
    s_add_u32 s52, s12, s74
    s_addc_u32 s53, s13, 0
    s_and_b32 s53, s53, 0xffff
    s_mov_b32 s54, 8192
    s_mov_b32 s55, 0x20000
    v_lshrrev_b32 v3, 3, v1
    v_and_b32 v6, 7, v1
    v_xor_b32 v6, v6, v3
    v_lshlrev_b32 v7, 10, v3
    v_lshl_add_u32 v8, v6, 4, v7
    v_add_u32 v9, 8192, v8
    v_add_u32 v10, 16384, v8
    v_add_u32 v11, 24576, v8
    s_lshl_b32 s74, s71, 17
    s_lshl_b32 s75, s68, 15
    s_add_u32 s99, s74, s75
    s_lshr_b32 s74, s70, 2
    s_and_b32 s75, s70, 3
    s_lshl_b32 s75, s75, 1
    s_add_u32 s98, s74, s75
    s_and_b32 s98, s98, 7
    s_mov_b32 s74, 0x12492493
    s_lshl_b32 s75, s68, 6
    v_add_u32 v3, s75, v1
    v_mul_hi_u32 v6, v3, s74
    v_mul_u32_u24 v7, 14, v6
    v_sub_u32 v3, v3, v7
    v_bfe_u32 v7, v6, 3, 1
    v_lshlrev_b32 v7, 2, v7
    v_xor_b32 v6, v6, v7
    v_mul_u32_u24 v6, 3584, v6
    v_lshl_add_u32 v52, v3, 4, v6
    v_add_u32 v3, s75, v1
    v_add_u32 v3, 256, v3
    v_mul_hi_u32 v6, v3, s74
    v_mul_u32_u24 v7, 14, v6
    v_sub_u32 v3, v3, v7
    v_bfe_u32 v7, v6, 3, 1
    v_lshlrev_b32 v7, 2, v7
    v_xor_b32 v6, v6, v7
    v_mul_u32_u24 v6, 3584, v6
    v_lshl_add_u32 v53, v3, 4, v6
    v_add_u32 v3, s75, v1
    v_add_u32 v3, 512, v3
    v_mul_hi_u32 v6, v3, s74
    v_mul_u32_u24 v7, 14, v6
    v_sub_u32 v3, v3, v7
    v_bfe_u32 v7, v6, 3, 1
    v_lshlrev_b32 v7, 2, v7
    v_xor_b32 v6, v6, v7
    v_mul_u32_u24 v6, 3584, v6
    v_lshl_add_u32 v54, v3, 4, v6
    v_add_u32 v3, s75, v1
    v_add_u32 v3, 768, v3
    v_mul_hi_u32 v6, v3, s74
    v_mul_u32_u24 v7, 14, v6
    v_sub_u32 v3, v3, v7
    v_bfe_u32 v7, v6, 3, 1
    v_lshlrev_b32 v7, 2, v7
    v_xor_b32 v6, v6, v7
    v_mul_u32_u24 v6, 3584, v6
    v_lshl_add_u32 v55, v3, 4, v6
    s_mul_i32 s100, s72, 224
    s_lshl_b32 s81, s68, 10
    s_lshl_b32 s64, s68, 12
    s_mov_b32 s66, s64
    s_cmp_lt_u32 s68, 2
    s_cselect_b64 s[64:65], -1, 0
    v_and_b32 v3, 7, v1
    v_lshrrev_b32 v6, 4, v1
    v_xor_b32 v6, v6, v3
    v_lshlrev_b32 v6, 4, v6
    v_lshl_add_u32 v6, v3, 7, v6
    v_bfe_u32 v7, v1, 3, 1
    v_lshl_add_u32 v6, v7, 10, v6
    v_add_u32 v56, s66, v6
    v_xor_b32 v57, 64, v56
    v_add_u32 v58, 61440, v56
    v_add_u32 v59, 61440, v57
    v_lshrrev_b32 v3, 4, v1
    v_bfe_u32 v6, v1, 2, 2
    v_and_b32 v7, 1, v3
    v_lshlrev_b32 v7, 2, v7
    v_xor_b32 v6, v6, v7
    v_lshl_add_u32 v6, v3, 3, v6
    v_xor_b32 v7, 4, v6
    v_and_b32 v3, 3, v1
    v_lshlrev_b32 v3, 3, v3
    v_add_u32 v3, 16384, v3
    v_mul_u32_u24 v6, 224, v6
    v_add_u32 v60, v6, v3
    v_mul_u32_u24 v7, 224, v7
    v_add_u32 v61, v7, v3
    v_add_u32 v62, 61440, v60
    v_add_u32 v63, 61440, v61
    s_lshl_b32 s74, s68, 5
    v_add_u32 v64, s74, v60
    v_add_u32 v65, s74, v61
    v_add_u32 v66, s74, v62
    v_add_u32 v67, s74, v63
    s_lshl_b32 s82, s68, 5
    s_add_u32 s82, s82, s70
    s_cmp_lt_u32 s82, 56
    s_cselect_b64 s[92:93], -1, 0
    s_cselect_b32 s94, s82, 0
    s_mul_hi_u32 s74, s94, 0x24924925
    s_mul_i32 s75, s74, 7
    s_sub_u32 s75, s94, s75
    s_mul_i32 s74, s74, 14
    s_lshl_b32 s83, s75, 1
    s_cmp_ge_u32 s75, 3
    s_cselect_b32 s84, 1, 0
    s_add_u32 s83, s83, s84
    s_cmp_eq_u32 s75, 6
    s_cselect_b32 s83, 6, s83
    s_cselect_b32 s85, 1, 0
    s_add_u32 s83, s83, s74
    s_lshl_b32 s83, s83, 14
    s_mov_b32 s84, 16384
    s_cmp_eq_u32 s85, 1
    s_cselect_b32 s84, 4096, s84
    s_add_u32 s84, s84, s83
    s_lshl_b32 s74, s69, 7
    s_add_u32 s83, s83, s74
    s_add_u32 s84, s84, s74
    v_lshrrev_b32 v3, 4, v1
    v_and_b32 v68, 1, v3
    v_lshlrev_b32 v68, 13, v68
    v_lshrrev_b32 v69, 1, v3
    v_mul_u32_u24 v69, 114688, v69
    v_add_u32 v68, v68, v69
    v_lshlrev_b32 v3, 12, v3
    s_cmp_eq_u32 s85, 1
    s_cselect_b64 vcc, -1, 0
    v_cndmask_b32 v3, v3, v68, vcc
    v_and_b32 v6, 15, v1
    v_lshl_add_u32 v3, v6, 3, v3
    s_mov_b64 exec, s[92:93]
    buffer_load_dwordx2 v[68:69], v3, s[44:47], s83 offen offset:0 nt
    buffer_load_dwordx2 v[70:71], v3, s[44:47], s83 offen offset:1024 nt
    buffer_load_dwordx2 v[72:73], v3, s[44:47], s83 offen offset:2048 nt
    buffer_load_dwordx2 v[74:75], v3, s[44:47], s83 offen offset:3072 nt
    buffer_load_dwordx2 v[76:77], v3, s[44:47], s84 offen offset:0 nt
    buffer_load_dwordx2 v[78:79], v3, s[44:47], s84 offen offset:1024 nt
    buffer_load_dwordx2 v[80:81], v3, s[44:47], s84 offen offset:2048 nt
    buffer_load_dwordx2 v[82:83], v3, s[44:47], s84 offen offset:3072 nt
    s_mov_b64 exec, -1
    v_lshlrev_b32 v100, 4, v0
    v_add_u32 v101, 4096, v100
    v_and_b32 v102, 3, v1
    v_lshrrev_b32 v3, 2, v1
    v_lshlrev_b32 v3, 12, v3
    v_cmp_eq_u32 vcc, 3, v102
    v_mov_b32 v102, 2147483632
    s_nop 0
    v_cndmask_b32 v102, v102, v3, vcc
    s_and_b32 s88, s69, 3
    s_lshl_b32 s88, s88, 3
    s_and_b32 s74, s70, 7
    s_add_u32 s88, s88, s74
    s_lshr_b32 s89, s69, 2
    s_lshl_b32 s89, s89, 2
    s_lshr_b32 s74, s70, 3
    s_add_u32 s89, s89, s74
    s_mul_i32 s74, s68, 57344
    s_mul_i32 s90, s89, 229376
    s_add_u32 s90, s90, s74
    s_add_u32 s90, s90, 2097152
    s_mul_i32 s91, s88, 229376
    s_add_u32 s91, s91, s74
    s_add_u32 s91, s91, 4194304
    v_lshlrev_b32 v3, 4, v1
    s_waitcnt lgkmcnt(0)
    s_lshl_b32 s74, s68, 9
    s_add_u32 s74, s74, 156160
    v_lshlrev_b32 v106, 4, v1
    v_add_u32 v106, s74, v106
    v_and_b32 v107, 7, v1
    v_lshlrev_b32 v107, 6, v107
    v_add_u32 v107, s74, v107
    v_and_b32 v103, 7, v0
    v_lshrrev_b32 v104, 3, v0
    v_sub_u32 v104, 31, v104
    v_lshlrev_b32 v105, 2, v103
    v_xor_b32 v104, v104, v105
    v_lshlrev_b32 v104, 2, v104
    v_lshl_add_u32 v104, v103, 10, v104
    v_add_u32 v105, 122880, v104
    v_cmp_gt_u32 vcc, 32, v1
    s_waitcnt vmcnt(10)
    v_lshlrev_b32 v124, 6, v1
    v_add_u32 v124, 48, v124
    v_mov_b32 v125, 1
    s_or_b32 s67, s2, s68
    s_cmp_eq_u32 s67, 0
    s_cselect_b64 exec, 15, 0
    global_store_dword v124, v125, s[24:25] sc1
    s_mov_b64 exec, -1
    s_and_saveexec_b64 s[82:83], vcc
    ds_write_b128 v106, v[40:43]
    s_mov_b64 exec, s[82:83]
    ds_read_b128 v[108:111], v107 offset:0
    ds_read_b128 v[112:115], v107 offset:16
    ds_read_b128 v[116:119], v107 offset:32
    ds_read_b128 v[120:123], v107 offset:48
    v_lshlrev_b32 v124, 16, v12
    v_and_b32 v125, 0xffff0000, v12
    v_lshlrev_b32 v126, 16, v16
    v_and_b32 v127, 0xffff0000, v16
    v_lshlrev_b32 v128, 16, v20
    v_and_b32 v129, 0xffff0000, v20
    v_lshlrev_b32 v130, 16, v24
    v_and_b32 v131, 0xffff0000, v24
    v_lshlrev_b32 v132, 16, v28
    v_and_b32 v133, 0xffff0000, v28
    v_lshlrev_b32 v172, 16, v32
    v_and_b32 v173, 0xffff0000, v32
    v_lshlrev_b32 v174, 16, v36
    v_and_b32 v175, 0xffff0000, v36
    s_lshl_b32 s76, s98, 7
    s_add_u32 s76, s76, s99
    s_mul_i32 s80, s98, 229376
    s_add_u32 s80, s80, s100
    s_add_u32 s98, s98, 1
    s_and_b32 s98, s98, 7
    s_add_u32 m0, s81, 16384
    s_nop 0
    buffer_load_dwordx4 v52, s[40:43], s80 offen lds
    s_waitcnt lgkmcnt(0)
    v_lshlrev_b32 v164, 16, v108
    v_and_b32 v166, 0xffff0000, v108
    v_lshlrev_b32 v168, 16, v109
    v_and_b32 v170, 0xffff0000, v109
    v_lshlrev_b32 v165, 16, v110
    v_and_b32 v167, 0xffff0000, v110
    v_lshlrev_b32 v169, 16, v111
    v_and_b32 v171, 0xffff0000, v111
    v_pk_mul_f32 v[188:189], v[170:171], v[124:125]
    v_pk_mul_f32 v[190:191], v[170:171], v[126:127]
    v_pk_fma_f32 v[188:189], v[168:169], v[126:127], v[188:189]
    v_pk_fma_f32 v[190:191], v[168:169], v[128:129], v[190:191]
    v_pk_fma_f32 v[188:189], v[166:167], v[128:129], v[188:189]
    v_pk_fma_f32 v[190:191], v[166:167], v[130:131], v[190:191]
    s_add_u32 m0, s81, 20480
    s_nop 0
    buffer_load_dwordx4 v53, s[40:43], s80 offen lds
    v_pk_fma_f32 v[188:189], v[164:165], v[130:131], v[188:189]
    v_pk_fma_f32 v[190:191], v[164:165], v[132:133], v[190:191]
    v_pk_mul_f32 v[188:189], v[188:189], v[172:173]
    v_pk_mul_f32 v[190:191], v[190:191], v[174:175]
    v_cvt_pk_bf16_f32 v192, v190, v188
    v_cvt_pk_bf16_f32 v193, v191, v189
    ds_write_b32 v105, v192 offset:0
    ds_write_b32 v105, v193 offset:128
    v_lshlrev_b32 v134, 16, v13
    v_and_b32 v135, 0xffff0000, v13
    v_lshlrev_b32 v136, 16, v17
    v_and_b32 v137, 0xffff0000, v17
    v_lshlrev_b32 v138, 16, v21
    v_and_b32 v139, 0xffff0000, v21
    v_lshlrev_b32 v140, 16, v25
    v_and_b32 v141, 0xffff0000, v25
    s_add_u32 m0, s81, 24576
    s_nop 0
    buffer_load_dwordx4 v54, s[40:43], s80 offen lds
    v_lshlrev_b32 v142, 16, v29
    v_and_b32 v143, 0xffff0000, v29
    v_lshlrev_b32 v176, 16, v33
    v_and_b32 v177, 0xffff0000, v33
    v_lshlrev_b32 v178, 16, v37
    v_and_b32 v179, 0xffff0000, v37
    v_lshlrev_b32 v164, 16, v112
    v_and_b32 v166, 0xffff0000, v112
    v_lshlrev_b32 v168, 16, v113
    v_and_b32 v170, 0xffff0000, v113
    v_lshlrev_b32 v165, 16, v114
    v_and_b32 v167, 0xffff0000, v114
    v_lshlrev_b32 v169, 16, v115
    v_and_b32 v171, 0xffff0000, v115
    s_add_u32 m0, s81, 28672
    s_nop 0
    s_mov_b64 exec, s[64:65]
    buffer_load_dwordx4 v55, s[40:43], s80 offen lds
    s_mov_b64 exec, -1
    v_pk_mul_f32 v[188:189], v[170:171], v[134:135]
    v_pk_mul_f32 v[190:191], v[170:171], v[136:137]
    v_pk_fma_f32 v[188:189], v[168:169], v[136:137], v[188:189]
    v_pk_fma_f32 v[190:191], v[168:169], v[138:139], v[190:191]
    v_pk_fma_f32 v[188:189], v[166:167], v[138:139], v[188:189]
    v_pk_fma_f32 v[190:191], v[166:167], v[140:141], v[190:191]
    v_pk_fma_f32 v[188:189], v[164:165], v[140:141], v[188:189]
    v_pk_fma_f32 v[190:191], v[164:165], v[142:143], v[190:191]
    v_pk_mul_f32 v[188:189], v[188:189], v[176:177]
    v_pk_mul_f32 v[190:191], v[190:191], v[178:179]
    v_cvt_pk_bf16_f32 v192, v190, v188
    v_cvt_pk_bf16_f32 v193, v191, v189
    ds_write_b32 v105, v192 offset:256
    ds_write_b32 v105, v193 offset:384
    v_lshlrev_b32 v144, 16, v14
    v_and_b32 v145, 0xffff0000, v14
    s_add_u32 m0, s66, 0
    s_nop 0
    buffer_load_dwordx4 v8, s[28:31], s76 offen lds
    v_lshlrev_b32 v146, 16, v18
    v_and_b32 v147, 0xffff0000, v18
    v_lshlrev_b32 v148, 16, v22
    v_and_b32 v149, 0xffff0000, v22
    v_lshlrev_b32 v150, 16, v26
    v_and_b32 v151, 0xffff0000, v26
    v_lshlrev_b32 v152, 16, v30
    v_and_b32 v153, 0xffff0000, v30
    v_lshlrev_b32 v180, 16, v34
    v_and_b32 v181, 0xffff0000, v34
    v_lshlrev_b32 v182, 16, v38
    v_and_b32 v183, 0xffff0000, v38
    v_lshlrev_b32 v164, 16, v116
    v_and_b32 v166, 0xffff0000, v116
    s_add_u32 m0, s66, 1024
    s_nop 0
    buffer_load_dwordx4 v9, s[28:31], s76 offen lds
    v_lshlrev_b32 v168, 16, v117
    v_and_b32 v170, 0xffff0000, v117
    v_lshlrev_b32 v165, 16, v118
    v_and_b32 v167, 0xffff0000, v118
    v_lshlrev_b32 v169, 16, v119
    v_and_b32 v171, 0xffff0000, v119
    v_pk_mul_f32 v[188:189], v[170:171], v[144:145]
    v_pk_mul_f32 v[190:191], v[170:171], v[146:147]
    v_pk_fma_f32 v[188:189], v[168:169], v[146:147], v[188:189]
    v_pk_fma_f32 v[190:191], v[168:169], v[148:149], v[190:191]
    v_pk_fma_f32 v[188:189], v[166:167], v[148:149], v[188:189]
    v_pk_fma_f32 v[190:191], v[166:167], v[150:151], v[190:191]
    v_pk_fma_f32 v[188:189], v[164:165], v[150:151], v[188:189]
    v_pk_fma_f32 v[190:191], v[164:165], v[152:153], v[190:191]
    s_add_u32 m0, s66, 2048
    s_nop 0
    buffer_load_dwordx4 v10, s[28:31], s76 offen lds
    v_pk_mul_f32 v[188:189], v[188:189], v[180:181]
    v_pk_mul_f32 v[190:191], v[190:191], v[182:183]
    v_cvt_pk_bf16_f32 v192, v190, v188
    v_cvt_pk_bf16_f32 v193, v191, v189
    ds_write_b32 v105, v192 offset:512
    ds_write_b32 v105, v193 offset:640
    v_lshlrev_b32 v154, 16, v15
    v_and_b32 v155, 0xffff0000, v15
    v_lshlrev_b32 v156, 16, v19
    v_and_b32 v157, 0xffff0000, v19
    v_lshlrev_b32 v158, 16, v23
    v_and_b32 v159, 0xffff0000, v23
    v_lshlrev_b32 v160, 16, v27
    v_and_b32 v161, 0xffff0000, v27
    v_lshlrev_b32 v162, 16, v31
    v_and_b32 v163, 0xffff0000, v31
    s_add_u32 m0, s66, 3072
    s_nop 0
    buffer_load_dwordx4 v11, s[28:31], s76 offen lds
    v_lshlrev_b32 v184, 16, v35
    v_and_b32 v185, 0xffff0000, v35
    v_lshlrev_b32 v186, 16, v39
    v_and_b32 v187, 0xffff0000, v39
    v_lshlrev_b32 v164, 16, v120
    v_and_b32 v166, 0xffff0000, v120
    v_lshlrev_b32 v168, 16, v121
    v_and_b32 v170, 0xffff0000, v121
    v_lshlrev_b32 v165, 16, v122
    v_and_b32 v167, 0xffff0000, v122
    v_lshlrev_b32 v169, 16, v123
    v_and_b32 v171, 0xffff0000, v123
    v_pk_mul_f32 v[188:189], v[170:171], v[154:155]
    v_pk_mul_f32 v[190:191], v[170:171], v[156:157]
    v_pk_fma_f32 v[188:189], v[168:169], v[156:157], v[188:189]
    v_pk_fma_f32 v[190:191], v[168:169], v[158:159], v[190:191]
    v_pk_fma_f32 v[188:189], v[166:167], v[158:159], v[188:189]
    v_pk_fma_f32 v[190:191], v[166:167], v[160:161], v[190:191]
    v_pk_fma_f32 v[188:189], v[164:165], v[160:161], v[188:189]
    v_pk_fma_f32 v[190:191], v[164:165], v[162:163], v[190:191]
    v_pk_mul_f32 v[188:189], v[188:189], v[184:185]
    v_pk_mul_f32 v[190:191], v[190:191], v[186:187]
    v_cvt_pk_bf16_f32 v192, v190, v188
    v_cvt_pk_bf16_f32 v193, v191, v189
    ds_write_b32 v105, v192 offset:768
    ds_write_b32 v105, v193 offset:896
    v_lshrrev_b32 v103, 3, v0
    v_and_b32 v104, 7, v0
    v_lshrrev_b32 v20, 3, v103
    v_xor_b32 v20, v20, v104
    v_lshlrev_b32 v20, 4, v20
    v_lshl_add_u32 v20, v103, 7, v20
    v_add_u32 v20, 122880, v20
    v_xor_b32 v21, 64, v20
    v_lshlrev_b32 v103, 12, v103
    v_lshl_add_u32 v103, v104, 4, v103
    s_lshl_b32 s74, s69, 18
    s_lshl_b32 s75, s70, 7
    s_sub_u32 s74, s74, s75
    s_add_u32 s82, s74, 3968
    s_add_u32 s83, s82, 131072
    s_waitcnt lgkmcnt(0)
    s_barrier
    ds_read_b128 v[12:15], v20
    ds_read_b128 v[16:19], v21 offset:4096
    s_waitcnt lgkmcnt(0)
    buffer_store_dwordx4 v[12:15], v103, s[48:51], s82 offen sc1
    buffer_store_dwordx4 v[16:19], v103, s[48:51], s83 offen sc1
    s_lshl_b32 s76, s98, 7
    s_add_u32 s76, s76, s99
    s_mul_i32 s80, s98, 229376
    s_add_u32 s80, s80, s100
    s_add_u32 s98, s98, 1
    s_and_b32 s98, s98, 7
    s_add_u32 m0, s81, 47104
    s_nop 0
    buffer_load_dwordx4 v52, s[40:43], s80 offen lds
    s_add_u32 m0, s81, 51200
    s_nop 0
    buffer_load_dwordx4 v53, s[40:43], s80 offen lds
    s_add_u32 m0, s81, 55296
    s_nop 0
    buffer_load_dwordx4 v54, s[40:43], s80 offen lds
    s_add_u32 m0, s81, 59392
    s_nop 0
    s_mov_b64 exec, s[64:65]
    buffer_load_dwordx4 v55, s[40:43], s80 offen lds
    s_mov_b64 exec, -1
    s_add_u32 m0, s66, 30720
    s_nop 0
    buffer_load_dwordx4 v8, s[28:31], s76 offen lds
    s_add_u32 m0, s66, 31744
    s_nop 0
    buffer_load_dwordx4 v9, s[28:31], s76 offen lds
    s_add_u32 m0, s66, 32768
    s_nop 0
    buffer_load_dwordx4 v10, s[28:31], s76 offen lds
    s_add_u32 m0, s66, 33792
    s_nop 0
    buffer_load_dwordx4 v11, s[28:31], s76 offen lds
    s_waitcnt vmcnt(27)
    v_lshlrev_b32 v22, 16, v44
    v_and_b32 v23, 0xffff0000, v44
    v_pk_mul_f32 v[110:111], v[22:23], v[22:23]
    v_mov_b32 v108, v22
    v_mov_b32 v109, v23
    v_lshlrev_b32 v22, 16, v45
    v_and_b32 v23, 0xffff0000, v45
    v_pk_fma_f32 v[110:111], v[22:23], v[22:23], v[110:111]
    v_pk_add_f32 v[108:109], v[108:109], v[22:23]
    v_lshlrev_b32 v22, 16, v46
    v_and_b32 v23, 0xffff0000, v46
    v_pk_fma_f32 v[110:111], v[22:23], v[22:23], v[110:111]
    v_pk_add_f32 v[108:109], v[108:109], v[22:23]
    v_lshlrev_b32 v22, 16, v47
    v_and_b32 v23, 0xffff0000, v47
    v_pk_fma_f32 v[110:111], v[22:23], v[22:23], v[110:111]
    v_pk_add_f32 v[108:109], v[108:109], v[22:23]
    v_add_f32 v108, v108, v109
    v_add_f32 v110, v110, v111
    v_lshlrev_b32 v22, 16, v48
    v_and_b32 v23, 0xffff0000, v48
    v_pk_mul_f32 v[114:115], v[22:23], v[22:23]
    v_mov_b32 v112, v22
    v_mov_b32 v113, v23
    v_lshlrev_b32 v22, 16, v49
    v_and_b32 v23, 0xffff0000, v49
    v_pk_fma_f32 v[114:115], v[22:23], v[22:23], v[114:115]
    v_pk_add_f32 v[112:113], v[112:113], v[22:23]
    v_lshlrev_b32 v22, 16, v50
    v_and_b32 v23, 0xffff0000, v50
    v_pk_fma_f32 v[114:115], v[22:23], v[22:23], v[114:115]
    v_pk_add_f32 v[112:113], v[112:113], v[22:23]
    v_lshlrev_b32 v22, 16, v51
    v_and_b32 v23, 0xffff0000, v51
    v_pk_fma_f32 v[114:115], v[22:23], v[22:23], v[114:115]
    v_pk_add_f32 v[112:113], v[112:113], v[22:23]
    v_add_f32 v112, v112, v113
    v_add_f32 v114, v114, v115
    v_add_f32_dpp v108, v108, v108 row_shr:1 row_mask:0xf bank_mask:0xf bound_ctrl:0
    v_add_f32_dpp v110, v110, v110 row_shr:1 row_mask:0xf bank_mask:0xf bound_ctrl:0
    v_add_f32_dpp v112, v112, v112 row_shr:1 row_mask:0xf bank_mask:0xf bound_ctrl:0
    v_add_f32_dpp v114, v114, v114 row_shr:1 row_mask:0xf bank_mask:0xf bound_ctrl:0
    v_add_f32_dpp v108, v108, v108 row_shr:2 row_mask:0xf bank_mask:0xf bound_ctrl:0
    v_add_f32_dpp v110, v110, v110 row_shr:2 row_mask:0xf bank_mask:0xf bound_ctrl:0
    v_add_f32_dpp v112, v112, v112 row_shr:2 row_mask:0xf bank_mask:0xf bound_ctrl:0
    v_add_f32_dpp v114, v114, v114 row_shr:2 row_mask:0xf bank_mask:0xf bound_ctrl:0
    v_add_f32_dpp v108, v108, v108 row_shr:4 row_mask:0xf bank_mask:0xf bound_ctrl:0
    v_add_f32_dpp v110, v110, v110 row_shr:4 row_mask:0xf bank_mask:0xf bound_ctrl:0
    v_add_f32_dpp v112, v112, v112 row_shr:4 row_mask:0xf bank_mask:0xf bound_ctrl:0
    v_add_f32_dpp v114, v114, v114 row_shr:4 row_mask:0xf bank_mask:0xf bound_ctrl:0
    v_add_f32_dpp v108, v108, v108 row_shr:8 row_mask:0xf bank_mask:0xf bound_ctrl:0
    v_add_f32_dpp v110, v110, v110 row_shr:8 row_mask:0xf bank_mask:0xf bound_ctrl:0
    v_add_f32_dpp v112, v112, v112 row_shr:8 row_mask:0xf bank_mask:0xf bound_ctrl:0
    v_add_f32_dpp v114, v114, v114 row_shr:8 row_mask:0xf bank_mask:0xf bound_ctrl:0
    v_add_f32_dpp v108, v108, v108 row_bcast:15 row_mask:0xa bank_mask:0xf
    v_add_f32_dpp v110, v110, v110 row_bcast:15 row_mask:0xa bank_mask:0xf
    v_add_f32_dpp v112, v112, v112 row_bcast:15 row_mask:0xa bank_mask:0xf
    v_add_f32_dpp v114, v114, v114 row_bcast:15 row_mask:0xa bank_mask:0xf
    v_add_f32_dpp v108, v108, v108 row_bcast:31 row_mask:0xc bank_mask:0xf
    v_add_f32_dpp v110, v110, v110 row_bcast:31 row_mask:0xc bank_mask:0xf
    v_add_f32_dpp v112, v112, v112 row_bcast:31 row_mask:0xc bank_mask:0xf
    v_add_f32_dpp v114, v114, v114 row_bcast:31 row_mask:0xc bank_mask:0xf
    s_mov_b32 s82, 0x3b000000
    s_mov_b32 s83, 0x3727c5ac
    v_mul_f32 v108, s82, v108
    v_mul_f32 v110, s82, v110
    v_fma_f32 v110, -v108, v108, v110
    v_max_f32 v110, 0, v110
    v_cvt_pk_bf16_f32 v22, v108, v110
    v_lshlrev_b32 v40, 16, v22
    v_and_b32 v110, 0xffff0000, v22
    v_add_f32 v110, s83, v110
    v_cvt_pk_bf16_f32 v22, v110, v110
    v_lshlrev_b32 v110, 16, v22
    v_sqrt_f32 v110, v110
    s_nop 0
    v_cvt_pk_bf16_f32 v22, v110, v110
    v_lshlrev_b32 v110, 16, v22
    v_rcp_f32 v41, v110
    v_mul_f32 v112, s82, v112
    v_mul_f32 v114, s82, v114
    v_fma_f32 v114, -v112, v112, v114
    v_max_f32 v114, 0, v114
    v_cvt_pk_bf16_f32 v22, v112, v114
    v_lshlrev_b32 v42, 16, v22
    v_and_b32 v114, 0xffff0000, v22
    v_add_f32 v114, s83, v114
    v_cvt_pk_bf16_f32 v22, v114, v114
    v_lshlrev_b32 v114, 16, v22
    v_sqrt_f32 v114, v114
    s_nop 0
    v_cvt_pk_bf16_f32 v22, v114, v114
    v_lshlrev_b32 v114, 16, v22
    v_rcp_f32 v43, v114
    s_mov_b32 s84, 0x05040100
    s_mov_b32 s85, 0x07060302
    s_waitcnt vmcnt(19)
    v_perm_b32 v24, v70, v68, s84
    v_perm_b32 v25, v74, v72, s84
    v_perm_b32 v26, v78, v76, s84
    v_perm_b32 v27, v82, v80, s84
    v_perm_b32 v28, v70, v68, s85
    v_perm_b32 v29, v74, v72, s85
    v_perm_b32 v30, v78, v76, s85
    v_perm_b32 v31, v82, v80, s85
    v_perm_b32 v32, v71, v69, s84
    v_perm_b32 v33, v75, v73, s84
    v_perm_b32 v34, v79, v77, s84
    v_perm_b32 v35, v83, v81, s84
    v_perm_b32 v36, v71, v69, s85
    v_perm_b32 v37, v75, v73, s85
    v_perm_b32 v38, v79, v77, s85
    v_perm_b32 v39, v83, v81, s85
    s_lshl_b32 s74, s101, 3
    s_add_u32 s74, s74, 11534336
    v_mov_b32 v22, 0
    s_mov_b32 s82, 0
    s_mov_b32 s83, 0x80000000
    s_mov_b64 exec, s[82:83]
    buffer_store_dwordx4 v[40:43], v22, s[48:51], s74 offen sc1
    s_mov_b64 exec, -1
    s_mul_i32 s74, s69, 229376
    s_lshl_b32 s75, s94, 12
    s_add_u32 s74, s74, s75
    s_add_u32 s74, s74, 2097152
    v_lshlrev_b32 v104, 4, v1
    s_mov_b64 exec, s[92:93]
    buffer_store_dwordx4 v[24:27], v104, s[48:51], s74 offen offset:0 sc1
    buffer_store_dwordx4 v[28:31], v104, s[48:51], s74 offen offset:1024 sc1
    buffer_store_dwordx4 v[32:35], v104, s[48:51], s74 offen offset:2048 sc1
    buffer_store_dwordx4 v[36:39], v104, s[48:51], s74 offen offset:3072 sc1
    s_mov_b64 exec, -1
    v_mov_b32 v105, 0x3f803f80
    v_accvgpr_write_b32 a224, v105
    v_accvgpr_write_b32 a225, v105
    v_accvgpr_write_b32 a226, v105
    v_accvgpr_write_b32 a227, v105
    s_and_b32 s75, s2, 3
    s_lshl_b32 s75, s75, 6
    s_add_u32 s75, s75, 48
    v_mov_b32 v106, s75
    s_cmp_eq_u32 s68, 0
    s_cselect_b64 exec, 1, 0
    global_load_dword v107, v106, s[24:25] sc1
    s_mov_b64 exec, -1
    s_waitcnt vmcnt(16)
    s_barrier
    ds_read_b128 v[220:223], v56 offset:0
    ds_read_b128 v[224:227], v56 offset:2048
    ds_read_b64_tr_b16 v[164:165], v60 offset:0
    ds_read_b64_tr_b16 v[166:167], v61 offset:0
    ds_read_b64_tr_b16 v[168:169], v60 offset:32
    ds_read_b64_tr_b16 v[170:171], v61 offset:32
    ds_read_b64_tr_b16 v[172:173], v60 offset:64
    ds_read_b64_tr_b16 v[174:175], v61 offset:64
    ds_read_b64_tr_b16 v[176:177], v60 offset:96
    ds_read_b64_tr_b16 v[178:179], v61 offset:96
    ds_read_b64_tr_b16 v[180:181], v60 offset:128
    ds_read_b64_tr_b16 v[182:183], v61 offset:128
    ds_read_b64_tr_b16 v[184:185], v60 offset:160
    ds_read_b64_tr_b16 v[186:187], v61 offset:160
    ds_read_b64_tr_b16 v[188:189], v60 offset:192
    ds_read_b64_tr_b16 v[190:191], v61 offset:192
    ds_read_b64_tr_b16 v[68:69], v64 offset:0
    ds_read_b64_tr_b16 v[70:71], v65 offset:0
    ds_read_b64_tr_b16 v[72:73], v64 offset:128
    ds_read_b64_tr_b16 v[74:75], v65 offset:128
    s_waitcnt lgkmcnt(0)
    v_mfma_f32_16x16x32_bf16 v[108:111], v[164:167], v[220:223], 0
    ds_read_b128 v[228:231], v57 offset:0
    ds_read_b128 v[232:235], v57 offset:2048
    s_lshl_b32 s76, s98, 7
    s_add_u32 s76, s76, s99
    s_mul_i32 s80, s98, 229376
    s_add_u32 s80, s80, s100
    s_add_u32 s98, s98, 1
    s_and_b32 s98, s98, 7
    s_add_u32 m0, s81, 77824
    v_mfma_f32_16x16x32_bf16 v[112:115], v[164:167], v[224:227], 0
    buffer_load_dwordx4 v52, s[40:43], s80 offen lds
    ds_read_b64_tr_b16 v[192:193], v60 offset:7168
    ds_read_b64_tr_b16 v[194:195], v61 offset:7168
    v_mfma_f32_16x16x32_bf16 v[116:119], v[168:171], v[220:223], 0
    ds_read_b64_tr_b16 v[196:197], v60 offset:7200
    ds_read_b64_tr_b16 v[198:199], v61 offset:7200
    v_mfma_f32_16x16x32_bf16 v[120:123], v[168:171], v[224:227], 0
    ds_read_b64_tr_b16 v[200:201], v60 offset:7232
    ds_read_b64_tr_b16 v[202:203], v61 offset:7232
    s_add_u32 m0, s81, 81920
    v_mfma_f32_16x16x32_bf16 v[124:127], v[172:175], v[220:223], 0
    buffer_load_dwordx4 v53, s[40:43], s80 offen lds
    ds_read_b64_tr_b16 v[204:205], v60 offset:7264
    ds_read_b64_tr_b16 v[206:207], v61 offset:7264
    v_mfma_f32_16x16x32_bf16 v[128:131], v[172:175], v[224:227], 0
    ds_read_b64_tr_b16 v[208:209], v60 offset:7296
    ds_read_b64_tr_b16 v[210:211], v61 offset:7296
    v_mfma_f32_16x16x32_bf16 v[132:135], v[176:179], v[220:223], 0
    ds_read_b64_tr_b16 v[212:213], v60 offset:7328
    s_add_u32 m0, s81, 86016
    v_mfma_f32_16x16x32_bf16 v[136:139], v[176:179], v[224:227], 0
    buffer_load_dwordx4 v54, s[40:43], s80 offen lds
    ds_read_b64_tr_b16 v[214:215], v61 offset:7328
    v_mfma_f32_16x16x32_bf16 v[140:143], v[180:183], v[220:223], 0
    ds_read_b64_tr_b16 v[216:217], v60 offset:7360
    v_mfma_f32_16x16x32_bf16 v[144:147], v[180:183], v[224:227], 0
    ds_read_b64_tr_b16 v[218:219], v61 offset:7360
    s_add_u32 m0, s81, 90112
    v_mfma_f32_16x16x32_bf16 v[148:151], v[184:187], v[220:223], 0
    s_mov_b64 exec, s[64:65]
    buffer_load_dwordx4 v55, s[40:43], s80 offen lds
    s_mov_b64 exec, -1
    ds_read_b64_tr_b16 v[76:77], v64 offset:7168
    v_mfma_f32_16x16x32_bf16 v[152:155], v[184:187], v[224:227], 0
    ds_read_b64_tr_b16 v[78:79], v65 offset:7168
    v_mfma_f32_16x16x32_bf16 v[156:159], v[188:191], v[220:223], 0
    ds_read_b64_tr_b16 v[80:81], v64 offset:7296
    s_add_u32 m0, s66, 61440
    v_mfma_f32_16x16x32_bf16 v[160:163], v[188:191], v[224:227], 0
    buffer_load_dwordx4 v8, s[28:31], s76 offen lds
    ds_read_b64_tr_b16 v[82:83], v65 offset:7296
    v_mfma_f32_16x16x32_bf16 v[44:47], v[68:71], a[224:227], 0
    v_mfma_f32_16x16x32_bf16 v[48:51], v[72:75], a[224:227], 0
    s_waitcnt lgkmcnt(0)
    s_waitcnt vmcnt(11)
    s_barrier
    v_mfma_f32_16x16x32_bf16 v[108:111], v[192:195], v[228:231], v[108:111]
    ds_read_b128 v[220:223], v56 offset:30720
    ds_read_b128 v[224:227], v56 offset:32768
    s_add_u32 m0, s66, 62464
    v_mfma_f32_16x16x32_bf16 v[112:115], v[192:195], v[232:235], v[112:115]
    buffer_load_dwordx4 v9, s[28:31], s76 offen lds
    ds_read_b64_tr_b16 v[164:165], v60 offset:30720
    ds_read_b64_tr_b16 v[166:167], v61 offset:30720
    v_mfma_f32_16x16x32_bf16 v[116:119], v[196:199], v[228:231], v[116:119]
    ds_read_b64_tr_b16 v[168:169], v60 offset:30752
    ds_read_b64_tr_b16 v[170:171], v61 offset:30752
    v_mfma_f32_16x16x32_bf16 v[120:123], v[196:199], v[232:235], v[120:123]
    ds_read_b64_tr_b16 v[172:173], v60 offset:30784
    ds_read_b64_tr_b16 v[174:175], v61 offset:30784
    s_add_u32 m0, s66, 63488
    v_mfma_f32_16x16x32_bf16 v[124:127], v[200:203], v[228:231], v[124:127]
    buffer_load_dwordx4 v10, s[28:31], s76 offen lds
    ds_read_b64_tr_b16 v[176:177], v60 offset:30816
    ds_read_b64_tr_b16 v[178:179], v61 offset:30816
    v_mfma_f32_16x16x32_bf16 v[128:131], v[200:203], v[232:235], v[128:131]
    ds_read_b64_tr_b16 v[180:181], v60 offset:30848
    ds_read_b64_tr_b16 v[182:183], v61 offset:30848
    v_mfma_f32_16x16x32_bf16 v[132:135], v[204:207], v[228:231], v[132:135]
    ds_read_b64_tr_b16 v[184:185], v60 offset:30880
    s_add_u32 m0, s66, 64512
    v_mfma_f32_16x16x32_bf16 v[136:139], v[204:207], v[232:235], v[136:139]
    buffer_load_dwordx4 v11, s[28:31], s76 offen lds
    ds_read_b64_tr_b16 v[186:187], v61 offset:30880
    v_mfma_f32_16x16x32_bf16 v[140:143], v[208:211], v[228:231], v[140:143]
    ds_read_b64_tr_b16 v[188:189], v60 offset:30912
    v_mfma_f32_16x16x32_bf16 v[144:147], v[208:211], v[232:235], v[144:147]
    ds_read_b64_tr_b16 v[190:191], v61 offset:30912
    s_lshl_b32 s76, s98, 7
    s_add_u32 s76, s76, s99
    s_mul_i32 s80, s98, 229376
    s_add_u32 s80, s80, s100
    s_add_u32 s98, s98, 1
    s_and_b32 s98, s98, 7
    s_add_u32 m0, s81, 108544
    v_mfma_f32_16x16x32_bf16 v[148:151], v[212:215], v[228:231], v[148:151]
    buffer_load_dwordx4 v52, s[40:43], s80 offen lds
    ds_read_b64_tr_b16 v[68:69], v64 offset:30720
    v_mfma_f32_16x16x32_bf16 v[152:155], v[212:215], v[232:235], v[152:155]
    ds_read_b64_tr_b16 v[70:71], v65 offset:30720
    v_mfma_f32_16x16x32_bf16 v[156:159], v[216:219], v[228:231], v[156:159]
    ds_read_b64_tr_b16 v[72:73], v64 offset:30848
    s_add_u32 m0, s81, 112640
    v_mfma_f32_16x16x32_bf16 v[160:163], v[216:219], v[232:235], v[160:163]
    buffer_load_dwordx4 v53, s[40:43], s80 offen lds
    ds_read_b64_tr_b16 v[74:75], v65 offset:30848
    v_mfma_f32_16x16x32_bf16 v[44:47], v[76:79], a[224:227], v[44:47]
    v_mfma_f32_16x16x32_bf16 v[48:51], v[80:83], a[224:227], v[48:51]
    s_waitcnt lgkmcnt(15)
    v_mfma_f32_16x16x32_bf16 v[108:111], v[164:167], v[220:223], v[108:111]
    ds_read_b128 v[228:231], v57 offset:30720
    ds_read_b128 v[232:235], v57 offset:32768
    s_add_u32 m0, s81, 116736
    v_mfma_f32_16x16x32_bf16 v[112:115], v[164:167], v[224:227], v[112:115]
    buffer_load_dwordx4 v54, s[40:43], s80 offen lds
    ds_read_b64_tr_b16 v[192:193], v60 offset:37888
    ds_read_b64_tr_b16 v[194:195], v61 offset:37888
    s_waitcnt lgkmcnt(15)
    v_mfma_f32_16x16x32_bf16 v[116:119], v[168:171], v[220:223], v[116:119]
    ds_read_b64_tr_b16 v[196:197], v60 offset:37920
    ds_read_b64_tr_b16 v[198:199], v61 offset:37920
    v_mfma_f32_16x16x32_bf16 v[120:123], v[168:171], v[224:227], v[120:123]
    ds_read_b64_tr_b16 v[200:201], v60 offset:37952
    ds_read_b64_tr_b16 v[202:203], v61 offset:37952
    s_add_u32 m0, s81, 120832
    v_mfma_f32_16x16x32_bf16 v[124:127], v[172:175], v[220:223], v[124:127]
    s_mov_b64 exec, s[64:65]
    buffer_load_dwordx4 v55, s[40:43], s80 offen lds
    s_mov_b64 exec, -1
    ds_read_b64_tr_b16 v[204:205], v60 offset:37984
    ds_read_b64_tr_b16 v[206:207], v61 offset:37984
    v_mfma_f32_16x16x32_bf16 v[128:131], v[172:175], v[224:227], v[128:131]
    ds_read_b64_tr_b16 v[208:209], v60 offset:38016
    ds_read_b64_tr_b16 v[210:211], v61 offset:38016
    s_waitcnt lgkmcnt(15)
    v_mfma_f32_16x16x32_bf16 v[132:135], v[176:179], v[220:223], v[132:135]
    ds_read_b64_tr_b16 v[212:213], v60 offset:38048
    s_add_u32 m0, s66, 92160
    v_mfma_f32_16x16x32_bf16 v[136:139], v[176:179], v[224:227], v[136:139]
    buffer_load_dwordx4 v8, s[28:31], s76 offen lds
    ds_read_b64_tr_b16 v[214:215], v61 offset:38048
    v_mfma_f32_16x16x32_bf16 v[140:143], v[180:183], v[220:223], v[140:143]
    ds_read_b64_tr_b16 v[216:217], v60 offset:38080
    v_mfma_f32_16x16x32_bf16 v[144:147], v[180:183], v[224:227], v[144:147]
    ds_read_b64_tr_b16 v[218:219], v61 offset:38080
    s_add_u32 m0, s66, 93184
    v_mfma_f32_16x16x32_bf16 v[148:151], v[184:187], v[220:223], v[148:151]
    buffer_load_dwordx4 v9, s[28:31], s76 offen lds
    ds_read_b64_tr_b16 v[76:77], v64 offset:37888
    v_mfma_f32_16x16x32_bf16 v[152:155], v[184:187], v[224:227], v[152:155]
    ds_read_b64_tr_b16 v[78:79], v65 offset:37888
    v_mfma_f32_16x16x32_bf16 v[156:159], v[188:191], v[220:223], v[156:159]
    ds_read_b64_tr_b16 v[80:81], v64 offset:38016
    s_add_u32 m0, s66, 94208
    v_mfma_f32_16x16x32_bf16 v[160:163], v[188:191], v[224:227], v[160:163]
    buffer_load_dwordx4 v10, s[28:31], s76 offen lds
    ds_read_b64_tr_b16 v[82:83], v65 offset:38016
    s_waitcnt lgkmcnt(15)
    v_mfma_f32_16x16x32_bf16 v[44:47], v[68:71], a[224:227], v[44:47]
    v_mfma_f32_16x16x32_bf16 v[48:51], v[72:75], a[224:227], v[48:51]
    s_waitcnt lgkmcnt(0)
    s_waitcnt vmcnt(7)
    s_barrier
    v_mfma_f32_16x16x32_bf16 v[108:111], v[192:195], v[228:231], v[108:111]
    ds_read_b128 v[220:223], v58 offset:0
    ds_read_b128 v[224:227], v58 offset:2048
    s_add_u32 m0, s66, 95232
    v_mfma_f32_16x16x32_bf16 v[112:115], v[192:195], v[232:235], v[112:115]
    buffer_load_dwordx4 v11, s[28:31], s76 offen lds
    ds_read_b64_tr_b16 v[164:165], v62 offset:0
    ds_read_b64_tr_b16 v[166:167], v63 offset:0
    v_mfma_f32_16x16x32_bf16 v[116:119], v[196:199], v[228:231], v[116:119]
    ds_read_b64_tr_b16 v[168:169], v62 offset:32
    ds_read_b64_tr_b16 v[170:171], v63 offset:32
    v_mfma_f32_16x16x32_bf16 v[120:123], v[196:199], v[232:235], v[120:123]
    s_mov_b32 s67, 0
    s_cmp_lg_u32 s68, 0
    s_cbranch_scc1 L_pk_R
L_pl_R:
    v_cmp_le_u32 vcc, 1, v107
    s_nop 1
    s_and_b32 s75, vcc_lo, 1
    s_cmp_eq_u32 s75, 1
    s_cbranch_scc1 L_pk_R
    s_sleep 4
    s_mov_b64 exec, 1
    global_load_dword v107, v106, s[24:25] sc1
    s_mov_b64 exec, -1
    s_waitcnt vmcnt(0)
    s_add_u32 s67, s67, 1
    s_cmp_lt_u32 s67, 0x40000
    s_cbranch_scc1 L_pl_R
L_pk_R:
    s_lshl_b32 s75, s69, 7
    s_add_u32 s75, s75, 14680064
    v_mov_b32 v106, s75
    v_mov_b32 v107, 1
    s_cmp_eq_u32 s68, 0
    s_cselect_b64 exec, 1, 0
    global_atomic_add v106, v107, s[26:27] sc1
    s_mov_b64 exec, -1
    ds_read_b64_tr_b16 v[172:173], v62 offset:64
    ds_read_b64_tr_b16 v[174:175], v63 offset:64
    s_lshl_b32 s76, s98, 7
    s_add_u32 s76, s76, s99
    s_mul_i32 s80, s98, 229376
    s_add_u32 s80, s80, s100
    s_add_u32 s98, s98, 1
    s_and_b32 s98, s98, 7
    s_add_u32 m0, s81, 16384
    v_mfma_f32_16x16x32_bf16 v[124:127], v[200:203], v[228:231], v[124:127]
    buffer_load_dwordx4 v52, s[40:43], s80 offen lds
    ds_read_b64_tr_b16 v[176:177], v62 offset:96
    ds_read_b64_tr_b16 v[178:179], v63 offset:96
    v_mfma_f32_16x16x32_bf16 v[128:131], v[200:203], v[232:235], v[128:131]
    ds_read_b64_tr_b16 v[180:181], v62 offset:128
    ds_read_b64_tr_b16 v[182:183], v63 offset:128
    v_mfma_f32_16x16x32_bf16 v[132:135], v[204:207], v[228:231], v[132:135]
    ds_read_b64_tr_b16 v[184:185], v62 offset:160
    s_add_u32 m0, s81, 20480
    v_mfma_f32_16x16x32_bf16 v[136:139], v[204:207], v[232:235], v[136:139]
    buffer_load_dwordx4 v53, s[40:43], s80 offen lds
    ds_read_b64_tr_b16 v[186:187], v63 offset:160
    v_mfma_f32_16x16x32_bf16 v[140:143], v[208:211], v[228:231], v[140:143]
    ds_read_b64_tr_b16 v[188:189], v62 offset:192
    v_mfma_f32_16x16x32_bf16 v[144:147], v[208:211], v[232:235], v[144:147]
    ds_read_b64_tr_b16 v[190:191], v63 offset:192
    s_add_u32 m0, s81, 24576
    v_mfma_f32_16x16x32_bf16 v[148:151], v[212:215], v[228:231], v[148:151]
    buffer_load_dwordx4 v54, s[40:43], s80 offen lds
    ds_read_b64_tr_b16 v[68:69], v66 offset:0
    v_mfma_f32_16x16x32_bf16 v[152:155], v[212:215], v[232:235], v[152:155]
    ds_read_b64_tr_b16 v[70:71], v67 offset:0
    v_mfma_f32_16x16x32_bf16 v[156:159], v[216:219], v[228:231], v[156:159]
    ds_read_b64_tr_b16 v[72:73], v66 offset:128
    s_add_u32 m0, s81, 28672
    v_mfma_f32_16x16x32_bf16 v[160:163], v[216:219], v[232:235], v[160:163]
    s_mov_b64 exec, s[64:65]
    buffer_load_dwordx4 v55, s[40:43], s80 offen lds
    s_mov_b64 exec, -1
    ds_read_b64_tr_b16 v[74:75], v67 offset:128
    v_mfma_f32_16x16x32_bf16 v[44:47], v[76:79], a[224:227], v[44:47]
    v_mfma_f32_16x16x32_bf16 v[48:51], v[80:83], a[224:227], v[48:51]
    s_waitcnt lgkmcnt(15)
    v_mfma_f32_16x16x32_bf16 v[108:111], v[164:167], v[220:223], v[108:111]
    ds_read_b128 v[228:231], v59 offset:0
    ds_read_b128 v[232:235], v59 offset:2048
    s_add_u32 m0, s66, 0
    v_mfma_f32_16x16x32_bf16 v[112:115], v[164:167], v[224:227], v[112:115]
    buffer_load_dwordx4 v8, s[28:31], s76 offen lds
    ds_read_b64_tr_b16 v[192:193], v62 offset:7168
    ds_read_b64_tr_b16 v[194:195], v63 offset:7168
    s_waitcnt lgkmcnt(15)
    v_mfma_f32_16x16x32_bf16 v[116:119], v[168:171], v[220:223], v[116:119]
    ds_read_b64_tr_b16 v[196:197], v62 offset:7200
    ds_read_b64_tr_b16 v[198:199], v63 offset:7200
    v_mfma_f32_16x16x32_bf16 v[120:123], v[168:171], v[224:227], v[120:123]
    ds_read_b64_tr_b16 v[200:201], v62 offset:7232
    ds_read_b64_tr_b16 v[202:203], v63 offset:7232
    s_add_u32 m0, s66, 1024
    v_mfma_f32_16x16x32_bf16 v[124:127], v[172:175], v[220:223], v[124:127]
    buffer_load_dwordx4 v9, s[28:31], s76 offen lds
    ds_read_b64_tr_b16 v[204:205], v62 offset:7264
    ds_read_b64_tr_b16 v[206:207], v63 offset:7264
    v_mfma_f32_16x16x32_bf16 v[128:131], v[172:175], v[224:227], v[128:131]
    ds_read_b64_tr_b16 v[208:209], v62 offset:7296
    ds_read_b64_tr_b16 v[210:211], v63 offset:7296
    s_waitcnt lgkmcnt(15)
    v_mfma_f32_16x16x32_bf16 v[132:135], v[176:179], v[220:223], v[132:135]
    ds_read_b64_tr_b16 v[212:213], v62 offset:7328
    s_add_u32 m0, s66, 2048
    v_mfma_f32_16x16x32_bf16 v[136:139], v[176:179], v[224:227], v[136:139]
    buffer_load_dwordx4 v10, s[28:31], s76 offen lds
    ds_read_b64_tr_b16 v[214:215], v63 offset:7328
    v_mfma_f32_16x16x32_bf16 v[140:143], v[180:183], v[220:223], v[140:143]
    ds_read_b64_tr_b16 v[216:217], v62 offset:7360
    v_mfma_f32_16x16x32_bf16 v[144:147], v[180:183], v[224:227], v[144:147]
    ds_read_b64_tr_b16 v[218:219], v63 offset:7360
    s_add_u32 m0, s66, 3072
    v_mfma_f32_16x16x32_bf16 v[148:151], v[184:187], v[220:223], v[148:151]
    buffer_load_dwordx4 v11, s[28:31], s76 offen lds
    ds_read_b64_tr_b16 v[76:77], v66 offset:7168
    v_mfma_f32_16x16x32_bf16 v[152:155], v[184:187], v[224:227], v[152:155]
    ds_read_b64_tr_b16 v[78:79], v67 offset:7168
    v_mfma_f32_16x16x32_bf16 v[156:159], v[188:191], v[220:223], v[156:159]
    ds_read_b64_tr_b16 v[80:81], v66 offset:7296
    s_lshl_b32 s76, s98, 7
    s_add_u32 s76, s76, s99
    s_mul_i32 s80, s98, 229376
    s_add_u32 s80, s80, s100
    s_add_u32 s98, s98, 1
    s_and_b32 s98, s98, 7
    s_add_u32 m0, s81, 47104
    v_mfma_f32_16x16x32_bf16 v[160:163], v[188:191], v[224:227], v[160:163]
    buffer_load_dwordx4 v52, s[40:43], s80 offen lds
    ds_read_b64_tr_b16 v[82:83], v67 offset:7296
    s_waitcnt lgkmcnt(15)
    v_mfma_f32_16x16x32_bf16 v[44:47], v[68:71], a[224:227], v[44:47]
    v_mfma_f32_16x16x32_bf16 v[48:51], v[72:75], a[224:227], v[48:51]
    s_waitcnt lgkmcnt(0)
    s_waitcnt vmcnt(10)
    s_barrier
    v_mfma_f32_16x16x32_bf16 v[108:111], v[192:195], v[228:231], v[108:111]
    ds_read_b128 v[220:223], v58 offset:30720
    ds_read_b128 v[224:227], v58 offset:32768
    s_add_u32 m0, s81, 51200
    v_mfma_f32_16x16x32_bf16 v[112:115], v[192:195], v[232:235], v[112:115]
    buffer_load_dwordx4 v53, s[40:43], s80 offen lds
    ds_read_b64_tr_b16 v[164:165], v62 offset:30720
    ds_read_b64_tr_b16 v[166:167], v63 offset:30720
    v_mfma_f32_16x16x32_bf16 v[116:119], v[196:199], v[228:231], v[116:119]
    ds_read_b64_tr_b16 v[168:169], v62 offset:30752
    ds_read_b64_tr_b16 v[170:171], v63 offset:30752
    v_mfma_f32_16x16x32_bf16 v[120:123], v[196:199], v[232:235], v[120:123]
    ds_read_b64_tr_b16 v[172:173], v62 offset:30784
    ds_read_b64_tr_b16 v[174:175], v63 offset:30784
    s_add_u32 m0, s81, 55296
    v_mfma_f32_16x16x32_bf16 v[124:127], v[200:203], v[228:231], v[124:127]
    buffer_load_dwordx4 v54, s[40:43], s80 offen lds
    ds_read_b64_tr_b16 v[176:177], v62 offset:30816
    ds_read_b64_tr_b16 v[178:179], v63 offset:30816
    v_mfma_f32_16x16x32_bf16 v[128:131], v[200:203], v[232:235], v[128:131]
    ds_read_b64_tr_b16 v[180:181], v62 offset:30848
    ds_read_b64_tr_b16 v[182:183], v63 offset:30848
    v_mfma_f32_16x16x32_bf16 v[132:135], v[204:207], v[228:231], v[132:135]
    ds_read_b64_tr_b16 v[184:185], v62 offset:30880
    s_add_u32 m0, s81, 59392
    v_mfma_f32_16x16x32_bf16 v[136:139], v[204:207], v[232:235], v[136:139]
    s_mov_b64 exec, s[64:65]
    buffer_load_dwordx4 v55, s[40:43], s80 offen lds
    s_mov_b64 exec, -1
    ds_read_b64_tr_b16 v[186:187], v63 offset:30880
    v_mfma_f32_16x16x32_bf16 v[140:143], v[208:211], v[228:231], v[140:143]
    ds_read_b64_tr_b16 v[188:189], v62 offset:30912
    v_mfma_f32_16x16x32_bf16 v[144:147], v[208:211], v[232:235], v[144:147]
    ds_read_b64_tr_b16 v[190:191], v63 offset:30912
    s_add_u32 m0, s66, 30720
    v_mfma_f32_16x16x32_bf16 v[148:151], v[212:215], v[228:231], v[148:151]
    buffer_load_dwordx4 v8, s[28:31], s76 offen lds
    ds_read_b64_tr_b16 v[68:69], v66 offset:30720
    v_mfma_f32_16x16x32_bf16 v[152:155], v[212:215], v[232:235], v[152:155]
    ds_read_b64_tr_b16 v[70:71], v67 offset:30720
    v_mfma_f32_16x16x32_bf16 v[156:159], v[216:219], v[228:231], v[156:159]
    ds_read_b64_tr_b16 v[72:73], v66 offset:30848
    s_add_u32 m0, s66, 31744
    v_mfma_f32_16x16x32_bf16 v[160:163], v[216:219], v[232:235], v[160:163]
    buffer_load_dwordx4 v9, s[28:31], s76 offen lds
    ds_read_b64_tr_b16 v[74:75], v67 offset:30848
    v_mfma_f32_16x16x32_bf16 v[44:47], v[76:79], a[224:227], v[44:47]
    v_mfma_f32_16x16x32_bf16 v[48:51], v[80:83], a[224:227], v[48:51]
    s_waitcnt lgkmcnt(15)
    v_mfma_f32_16x16x32_bf16 v[108:111], v[164:167], v[220:223], v[108:111]
    ds_read_b128 v[228:231], v59 offset:30720
    ds_read_b128 v[232:235], v59 offset:32768
    s_add_u32 m0, s66, 32768
    v_mfma_f32_16x16x32_bf16 v[112:115], v[164:167], v[224:227], v[112:115]
    buffer_load_dwordx4 v10, s[28:31], s76 offen lds
    ds_read_b64_tr_b16 v[192:193], v62 offset:37888
    ds_read_b64_tr_b16 v[194:195], v63 offset:37888
    s_waitcnt lgkmcnt(15)
    v_mfma_f32_16x16x32_bf16 v[116:119], v[168:171], v[220:223], v[116:119]
    ds_read_b64_tr_b16 v[196:197], v62 offset:37920
    ds_read_b64_tr_b16 v[198:199], v63 offset:37920
    v_mfma_f32_16x16x32_bf16 v[120:123], v[168:171], v[224:227], v[120:123]
    ds_read_b64_tr_b16 v[200:201], v62 offset:37952
    ds_read_b64_tr_b16 v[202:203], v63 offset:37952
    s_add_u32 m0, s66, 33792
    v_mfma_f32_16x16x32_bf16 v[124:127], v[172:175], v[220:223], v[124:127]
    buffer_load_dwordx4 v11, s[28:31], s76 offen lds
    ds_read_b64_tr_b16 v[204:205], v62 offset:37984
    ds_read_b64_tr_b16 v[206:207], v63 offset:37984
    v_mfma_f32_16x16x32_bf16 v[128:131], v[172:175], v[224:227], v[128:131]
    ds_read_b64_tr_b16 v[208:209], v62 offset:38016
    ds_read_b64_tr_b16 v[210:211], v63 offset:38016
    s_waitcnt lgkmcnt(15)
    v_mfma_f32_16x16x32_bf16 v[132:135], v[176:179], v[220:223], v[132:135]
    ds_read_b64_tr_b16 v[212:213], v62 offset:38048
    s_lshl_b32 s76, s98, 7
    s_add_u32 s76, s76, s99
    s_mul_i32 s80, s98, 229376
    s_add_u32 s80, s80, s100
    s_add_u32 s98, s98, 1
    s_and_b32 s98, s98, 7
    s_add_u32 m0, s81, 77824
    v_mfma_f32_16x16x32_bf16 v[136:139], v[176:179], v[224:227], v[136:139]
    buffer_load_dwordx4 v52, s[40:43], s80 offen lds
    ds_read_b64_tr_b16 v[214:215], v63 offset:38048
    v_mfma_f32_16x16x32_bf16 v[140:143], v[180:183], v[220:223], v[140:143]
    ds_read_b64_tr_b16 v[216:217], v62 offset:38080
    v_mfma_f32_16x16x32_bf16 v[144:147], v[180:183], v[224:227], v[144:147]
    ds_read_b64_tr_b16 v[218:219], v63 offset:38080
    s_add_u32 m0, s81, 81920
    v_mfma_f32_16x16x32_bf16 v[148:151], v[184:187], v[220:223], v[148:151]
    buffer_load_dwordx4 v53, s[40:43], s80 offen lds
    ds_read_b64_tr_b16 v[76:77], v66 offset:37888
    v_mfma_f32_16x16x32_bf16 v[152:155], v[184:187], v[224:227], v[152:155]
    ds_read_b64_tr_b16 v[78:79], v67 offset:37888
    v_mfma_f32_16x16x32_bf16 v[156:159], v[188:191], v[220:223], v[156:159]
    ds_read_b64_tr_b16 v[80:81], v66 offset:38016
    v_mfma_f32_16x16x32_bf16 v[160:163], v[188:191], v[224:227], v[160:163]
    ds_read_b64_tr_b16 v[82:83], v67 offset:38016
    s_waitcnt lgkmcnt(15)
    v_mfma_f32_16x16x32_bf16 v[44:47], v[68:71], a[224:227], v[44:47]
    v_mfma_f32_16x16x32_bf16 v[48:51], v[72:75], a[224:227], v[48:51]
    s_waitcnt lgkmcnt(0)
    s_waitcnt vmcnt(10)
    s_barrier
    v_mfma_f32_16x16x32_bf16 v[108:111], v[192:195], v[228:231], v[108:111]
    ds_read_b128 v[220:223], v56 offset:0
    ds_read_b128 v[224:227], v56 offset:2048
    s_add_u32 m0, s81, 86016
    v_mfma_f32_16x16x32_bf16 v[112:115], v[192:195], v[232:235], v[112:115]
    buffer_load_dwordx4 v54, s[40:43], s80 offen lds
    ds_read_b64_tr_b16 v[164:165], v60 offset:0
    ds_read_b64_tr_b16 v[166:167], v61 offset:0
    v_mfma_f32_16x16x32_bf16 v[116:119], v[196:199], v[228:231], v[116:119]
    ds_read_b64_tr_b16 v[168:169], v60 offset:32
    ds_read_b64_tr_b16 v[170:171], v61 offset:32
    v_mfma_f32_16x16x32_bf16 v[120:123], v[196:199], v[232:235], v[120:123]
    ds_read_b64_tr_b16 v[172:173], v60 offset:64
    ds_read_b64_tr_b16 v[174:175], v61 offset:64
    s_add_u32 m0, s81, 90112
    v_mfma_f32_16x16x32_bf16 v[124:127], v[200:203], v[228:231], v[124:127]
    s_mov_b64 exec, s[64:65]
    buffer_load_dwordx4 v55, s[40:43], s80 offen lds
    s_mov_b64 exec, -1
    ds_read_b64_tr_b16 v[176:177], v60 offset:96
    ds_read_b64_tr_b16 v[178:179], v61 offset:96
    v_mfma_f32_16x16x32_bf16 v[128:131], v[200:203], v[232:235], v[128:131]
    ds_read_b64_tr_b16 v[180:181], v60 offset:128
    ds_read_b64_tr_b16 v[182:183], v61 offset:128
    v_mfma_f32_16x16x32_bf16 v[132:135], v[204:207], v[228:231], v[132:135]
    ds_read_b64_tr_b16 v[184:185], v60 offset:160
    s_add_u32 m0, s66, 61440
    v_mfma_f32_16x16x32_bf16 v[136:139], v[204:207], v[232:235], v[136:139]
    buffer_load_dwordx4 v8, s[28:31], s76 offen lds
    ds_read_b64_tr_b16 v[186:187], v61 offset:160
    v_mfma_f32_16x16x32_bf16 v[140:143], v[208:211], v[228:231], v[140:143]
    ds_read_b64_tr_b16 v[188:189], v60 offset:192
    v_mfma_f32_16x16x32_bf16 v[144:147], v[208:211], v[232:235], v[144:147]
    ds_read_b64_tr_b16 v[190:191], v61 offset:192
    s_add_u32 m0, s66, 62464
    v_mfma_f32_16x16x32_bf16 v[148:151], v[212:215], v[228:231], v[148:151]
    buffer_load_dwordx4 v9, s[28:31], s76 offen lds
    ds_read_b64_tr_b16 v[68:69], v64 offset:0
    v_mfma_f32_16x16x32_bf16 v[152:155], v[212:215], v[232:235], v[152:155]
    ds_read_b64_tr_b16 v[70:71], v65 offset:0
    v_mfma_f32_16x16x32_bf16 v[156:159], v[216:219], v[228:231], v[156:159]
    ds_read_b64_tr_b16 v[72:73], v64 offset:128
    v_mfma_f32_16x16x32_bf16 v[160:163], v[216:219], v[232:235], v[160:163]
    ds_read_b64_tr_b16 v[74:75], v65 offset:128
    v_mfma_f32_16x16x32_bf16 v[44:47], v[76:79], a[224:227], v[44:47]
    v_mfma_f32_16x16x32_bf16 v[48:51], v[80:83], a[224:227], v[48:51]
    s_waitcnt lgkmcnt(15)
    v_mfma_f32_16x16x32_bf16 v[108:111], v[164:167], v[220:223], v[108:111]
    ds_read_b128 v[228:231], v57 offset:0
    ds_read_b128 v[232:235], v57 offset:2048
    s_add_u32 m0, s66, 63488
    v_mfma_f32_16x16x32_bf16 v[112:115], v[164:167], v[224:227], v[112:115]
    buffer_load_dwordx4 v10, s[28:31], s76 offen lds
    ds_read_b64_tr_b16 v[192:193], v60 offset:7168
    ds_read_b64_tr_b16 v[194:195], v61 offset:7168
    s_waitcnt lgkmcnt(15)
    v_mfma_f32_16x16x32_bf16 v[116:119], v[168:171], v[220:223], v[116:119]
    ds_read_b64_tr_b16 v[196:197], v60 offset:7200
    ds_read_b64_tr_b16 v[198:199], v61 offset:7200
    v_mfma_f32_16x16x32_bf16 v[120:123], v[168:171], v[224:227], v[120:123]
    ds_read_b64_tr_b16 v[200:201], v60 offset:7232
    ds_read_b64_tr_b16 v[202:203], v61 offset:7232
    s_add_u32 m0, s66, 64512
    v_mfma_f32_16x16x32_bf16 v[124:127], v[172:175], v[220:223], v[124:127]
    buffer_load_dwordx4 v11, s[28:31], s76 offen lds
    ds_read_b64_tr_b16 v[204:205], v60 offset:7264
    ds_read_b64_tr_b16 v[206:207], v61 offset:7264
    v_mfma_f32_16x16x32_bf16 v[128:131], v[172:175], v[224:227], v[128:131]
    ds_read_b64_tr_b16 v[208:209], v60 offset:7296
    ds_read_b64_tr_b16 v[210:211], v61 offset:7296
    s_waitcnt lgkmcnt(15)
    v_mfma_f32_16x16x32_bf16 v[132:135], v[176:179], v[220:223], v[132:135]
    ds_read_b64_tr_b16 v[212:213], v60 offset:7328
    s_lshl_b32 s76, s98, 7
    s_add_u32 s76, s76, s99
    s_mul_i32 s80, s98, 229376
    s_add_u32 s80, s80, s100
    s_add_u32 s98, s98, 1
    s_and_b32 s98, s98, 7
    s_add_u32 m0, s81, 108544
    v_mfma_f32_16x16x32_bf16 v[136:139], v[176:179], v[224:227], v[136:139]
    buffer_load_dwordx4 v52, s[40:43], s80 offen lds
    ds_read_b64_tr_b16 v[214:215], v61 offset:7328
    v_mfma_f32_16x16x32_bf16 v[140:143], v[180:183], v[220:223], v[140:143]
    ds_read_b64_tr_b16 v[216:217], v60 offset:7360
    v_mfma_f32_16x16x32_bf16 v[144:147], v[180:183], v[224:227], v[144:147]
    ds_read_b64_tr_b16 v[218:219], v61 offset:7360
    s_add_u32 m0, s81, 112640
    v_mfma_f32_16x16x32_bf16 v[148:151], v[184:187], v[220:223], v[148:151]
    buffer_load_dwordx4 v53, s[40:43], s80 offen lds
    ds_read_b64_tr_b16 v[76:77], v64 offset:7168
    v_mfma_f32_16x16x32_bf16 v[152:155], v[184:187], v[224:227], v[152:155]
    ds_read_b64_tr_b16 v[78:79], v65 offset:7168
    v_mfma_f32_16x16x32_bf16 v[156:159], v[188:191], v[220:223], v[156:159]
    ds_read_b64_tr_b16 v[80:81], v64 offset:7296
    v_mfma_f32_16x16x32_bf16 v[160:163], v[188:191], v[224:227], v[160:163]
    ds_read_b64_tr_b16 v[82:83], v65 offset:7296
    s_waitcnt lgkmcnt(15)
    v_mfma_f32_16x16x32_bf16 v[44:47], v[68:71], a[224:227], v[44:47]
    v_mfma_f32_16x16x32_bf16 v[48:51], v[72:75], a[224:227], v[48:51]
    s_waitcnt lgkmcnt(0)
    s_waitcnt vmcnt(10)
    s_barrier
    v_mfma_f32_16x16x32_bf16 v[108:111], v[192:195], v[228:231], v[108:111]
    ds_read_b128 v[220:223], v56 offset:30720
    ds_read_b128 v[224:227], v56 offset:32768
    s_add_u32 m0, s81, 116736
    v_mfma_f32_16x16x32_bf16 v[112:115], v[192:195], v[232:235], v[112:115]
    buffer_load_dwordx4 v54, s[40:43], s80 offen lds
    ds_read_b64_tr_b16 v[164:165], v60 offset:30720
    ds_read_b64_tr_b16 v[166:167], v61 offset:30720
    v_mfma_f32_16x16x32_bf16 v[116:119], v[196:199], v[228:231], v[116:119]
    ds_read_b64_tr_b16 v[168:169], v60 offset:30752
    ds_read_b64_tr_b16 v[170:171], v61 offset:30752
    v_mfma_f32_16x16x32_bf16 v[120:123], v[196:199], v[232:235], v[120:123]
    ds_read_b64_tr_b16 v[172:173], v60 offset:30784
    ds_read_b64_tr_b16 v[174:175], v61 offset:30784
    s_add_u32 m0, s81, 120832
    v_mfma_f32_16x16x32_bf16 v[124:127], v[200:203], v[228:231], v[124:127]
    s_mov_b64 exec, s[64:65]
    buffer_load_dwordx4 v55, s[40:43], s80 offen lds
    s_mov_b64 exec, -1
    ds_read_b64_tr_b16 v[176:177], v60 offset:30816
    ds_read_b64_tr_b16 v[178:179], v61 offset:30816
    v_mfma_f32_16x16x32_bf16 v[128:131], v[200:203], v[232:235], v[128:131]
    ds_read_b64_tr_b16 v[180:181], v60 offset:30848
    ds_read_b64_tr_b16 v[182:183], v61 offset:30848
    v_mfma_f32_16x16x32_bf16 v[132:135], v[204:207], v[228:231], v[132:135]
    ds_read_b64_tr_b16 v[184:185], v60 offset:30880
    s_add_u32 m0, s66, 92160
    v_mfma_f32_16x16x32_bf16 v[136:139], v[204:207], v[232:235], v[136:139]
    buffer_load_dwordx4 v8, s[28:31], s76 offen lds
    ds_read_b64_tr_b16 v[186:187], v61 offset:30880
    v_mfma_f32_16x16x32_bf16 v[140:143], v[208:211], v[228:231], v[140:143]
    ds_read_b64_tr_b16 v[188:189], v60 offset:30912
    v_mfma_f32_16x16x32_bf16 v[144:147], v[208:211], v[232:235], v[144:147]
    ds_read_b64_tr_b16 v[190:191], v61 offset:30912
    s_add_u32 m0, s66, 93184
    v_mfma_f32_16x16x32_bf16 v[148:151], v[212:215], v[228:231], v[148:151]
    buffer_load_dwordx4 v9, s[28:31], s76 offen lds
    ds_read_b64_tr_b16 v[68:69], v64 offset:30720
    v_mfma_f32_16x16x32_bf16 v[152:155], v[212:215], v[232:235], v[152:155]
    ds_read_b64_tr_b16 v[70:71], v65 offset:30720
    v_mfma_f32_16x16x32_bf16 v[156:159], v[216:219], v[228:231], v[156:159]
    ds_read_b64_tr_b16 v[72:73], v64 offset:30848
    v_mfma_f32_16x16x32_bf16 v[160:163], v[216:219], v[232:235], v[160:163]
    ds_read_b64_tr_b16 v[74:75], v65 offset:30848
    v_mfma_f32_16x16x32_bf16 v[44:47], v[76:79], a[224:227], v[44:47]
    v_mfma_f32_16x16x32_bf16 v[48:51], v[80:83], a[224:227], v[48:51]
    s_waitcnt lgkmcnt(15)
    v_mfma_f32_16x16x32_bf16 v[108:111], v[164:167], v[220:223], v[108:111]
    ds_read_b128 v[228:231], v57 offset:30720
    ds_read_b128 v[232:235], v57 offset:32768
    s_add_u32 m0, s66, 94208
    v_mfma_f32_16x16x32_bf16 v[112:115], v[164:167], v[224:227], v[112:115]
    buffer_load_dwordx4 v10, s[28:31], s76 offen lds
    ds_read_b64_tr_b16 v[192:193], v60 offset:37888
    ds_read_b64_tr_b16 v[194:195], v61 offset:37888
    s_waitcnt lgkmcnt(15)
    v_mfma_f32_16x16x32_bf16 v[116:119], v[168:171], v[220:223], v[116:119]
    ds_read_b64_tr_b16 v[196:197], v60 offset:37920
    ds_read_b64_tr_b16 v[198:199], v61 offset:37920
    v_mfma_f32_16x16x32_bf16 v[120:123], v[168:171], v[224:227], v[120:123]
    ds_read_b64_tr_b16 v[200:201], v60 offset:37952
    ds_read_b64_tr_b16 v[202:203], v61 offset:37952
    s_add_u32 m0, s66, 95232
    v_mfma_f32_16x16x32_bf16 v[124:127], v[172:175], v[220:223], v[124:127]
    buffer_load_dwordx4 v11, s[28:31], s76 offen lds
    ds_read_b64_tr_b16 v[204:205], v60 offset:37984
    ds_read_b64_tr_b16 v[206:207], v61 offset:37984
    v_mfma_f32_16x16x32_bf16 v[128:131], v[172:175], v[224:227], v[128:131]
    ds_read_b64_tr_b16 v[208:209], v60 offset:38016
    ds_read_b64_tr_b16 v[210:211], v61 offset:38016
    s_waitcnt lgkmcnt(15)
    v_mfma_f32_16x16x32_bf16 v[132:135], v[176:179], v[220:223], v[132:135]
    ds_read_b64_tr_b16 v[212:213], v60 offset:38048
    v_mfma_f32_16x16x32_bf16 v[136:139], v[176:179], v[224:227], v[136:139]
    buffer_load_dwordx4 v[84:87], v100, s[52:55], 0 offen nt
    ds_read_b64_tr_b16 v[214:215], v61 offset:38048
    v_mfma_f32_16x16x32_bf16 v[140:143], v[180:183], v[220:223], v[140:143]
    ds_read_b64_tr_b16 v[216:217], v60 offset:38080
    v_mfma_f32_16x16x32_bf16 v[144:147], v[180:183], v[224:227], v[144:147]
    ds_read_b64_tr_b16 v[218:219], v61 offset:38080
    v_mfma_f32_16x16x32_bf16 v[148:151], v[184:187], v[220:223], v[148:151]
    buffer_load_dwordx2 v[88:89], v100, s[52:55], 0 offen offset:16 nt
    ds_read_b64_tr_b16 v[76:77], v64 offset:37888
    v_mfma_f32_16x16x32_bf16 v[152:155], v[184:187], v[224:227], v[152:155]
    ds_read_b64_tr_b16 v[78:79], v65 offset:37888
    v_mfma_f32_16x16x32_bf16 v[156:159], v[188:191], v[220:223], v[156:159]
    ds_read_b64_tr_b16 v[80:81], v64 offset:38016
    v_mfma_f32_16x16x32_bf16 v[160:163], v[188:191], v[224:227], v[160:163]
    ds_read_b64_tr_b16 v[82:83], v65 offset:38016
    s_waitcnt lgkmcnt(15)
    v_mfma_f32_16x16x32_bf16 v[44:47], v[68:71], a[224:227], v[44:47]
    v_mfma_f32_16x16x32_bf16 v[48:51], v[72:75], a[224:227], v[48:51]
    s_waitcnt lgkmcnt(0)
    s_waitcnt vmcnt(10)
    s_barrier
    v_mfma_f32_16x16x32_bf16 v[108:111], v[192:195], v[228:231], v[108:111]
    ds_read_b128 v[220:223], v58 offset:0
    ds_read_b128 v[224:227], v58 offset:2048
    v_mfma_f32_16x16x32_bf16 v[112:115], v[192:195], v[232:235], v[112:115]
    buffer_load_dwordx4 v[92:95], v101, s[52:55], 0 offen nt
    ds_read_b64_tr_b16 v[164:165], v62 offset:0
    ds_read_b64_tr_b16 v[166:167], v63 offset:0
    v_mfma_f32_16x16x32_bf16 v[116:119], v[196:199], v[228:231], v[116:119]
    ds_read_b64_tr_b16 v[168:169], v62 offset:32
    ds_read_b64_tr_b16 v[170:171], v63 offset:32
    v_mfma_f32_16x16x32_bf16 v[120:123], v[196:199], v[232:235], v[120:123]
    s_lshr_b32 s82, s71, 2
    s_add_u32 s83, s82, 4
    s_lshr_b32 s84, s88, 3
    s_add_u32 s85, s84, 4
    s_lshl_b32 s75, s69, 7
    s_add_u32 s75, s75, 14680064
    v_mov_b32 v12, s75
    s_lshl_b32 s75, s89, 7
    s_add_u32 s75, s75, 14680064
    v_writelane_b32 v12, s75, 1
    s_lshl_b32 s75, s82, 7
    s_add_u32 s75, s75, 14680064
    v_writelane_b32 v12, s75, 2
    s_lshl_b32 s75, s83, 7
    s_add_u32 s75, s75, 14680064
    v_writelane_b32 v12, s75, 3
    s_lshl_b32 s75, s84, 7
    s_add_u32 s75, s75, 14680064
    v_writelane_b32 v12, s75, 4
    s_lshl_b32 s75, s85, 7
    s_add_u32 s75, s75, 14680064
    v_writelane_b32 v12, s75, 5
    s_cmp_eq_u32 s68, 0
    s_cselect_b64 exec, 63, 0
    global_load_dword v13, v12, s[26:27] sc1
    s_mov_b64 exec, -1
    ds_read_b64_tr_b16 v[172:173], v62 offset:64
    ds_read_b64_tr_b16 v[174:175], v63 offset:64
    v_mfma_f32_16x16x32_bf16 v[124:127], v[200:203], v[228:231], v[124:127]
    buffer_load_dwordx2 v[96:97], v101, s[52:55], 0 offen offset:16 nt
    ds_read_b64_tr_b16 v[176:177], v62 offset:96
    ds_read_b64_tr_b16 v[178:179], v63 offset:96
    v_mfma_f32_16x16x32_bf16 v[128:131], v[200:203], v[232:235], v[128:131]
    ds_read_b64_tr_b16 v[180:181], v62 offset:128
    ds_read_b64_tr_b16 v[182:183], v63 offset:128
    v_mfma_f32_16x16x32_bf16 v[132:135], v[204:207], v[228:231], v[132:135]
    ds_read_b64_tr_b16 v[184:185], v62 offset:160
    v_mfma_f32_16x16x32_bf16 v[136:139], v[204:207], v[232:235], v[136:139]
    buffer_load_dwordx2 v[6:7], v102, s[52:55], 0 offen
    ds_read_b64_tr_b16 v[186:187], v63 offset:160
    v_mfma_f32_16x16x32_bf16 v[140:143], v[208:211], v[228:231], v[140:143]
    ds_read_b64_tr_b16 v[188:189], v62 offset:192
    v_mfma_f32_16x16x32_bf16 v[144:147], v[208:211], v[232:235], v[144:147]
    ds_read_b64_tr_b16 v[190:191], v63 offset:192
    v_mfma_f32_16x16x32_bf16 v[148:151], v[212:215], v[228:231], v[148:151]
    ds_read_b64_tr_b16 v[68:69], v66 offset:0
    v_mfma_f32_16x16x32_bf16 v[152:155], v[212:215], v[232:235], v[152:155]
    ds_read_b64_tr_b16 v[70:71], v67 offset:0
    v_mfma_f32_16x16x32_bf16 v[156:159], v[216:219], v[228:231], v[156:159]
    ds_read_b64_tr_b16 v[72:73], v66 offset:128
    v_mfma_f32_16x16x32_bf16 v[160:163], v[216:219], v[232:235], v[160:163]
    ds_read_b64_tr_b16 v[74:75], v67 offset:128
    v_mfma_f32_16x16x32_bf16 v[44:47], v[76:79], a[224:227], v[44:47]
    v_mfma_f32_16x16x32_bf16 v[48:51], v[80:83], a[224:227], v[48:51]
    s_waitcnt lgkmcnt(15)
    v_mfma_f32_16x16x32_bf16 v[108:111], v[164:167], v[220:223], v[108:111]
    ds_read_b128 v[228:231], v59 offset:0
    ds_read_b128 v[232:235], v59 offset:2048
    v_mfma_f32_16x16x32_bf16 v[112:115], v[164:167], v[224:227], v[112:115]
    ds_read_b64_tr_b16 v[192:193], v62 offset:7168
    ds_read_b64_tr_b16 v[194:195], v63 offset:7168
    s_waitcnt lgkmcnt(15)
    v_mfma_f32_16x16x32_bf16 v[116:119], v[168:171], v[220:223], v[116:119]
    ds_read_b64_tr_b16 v[196:197], v62 offset:7200
    ds_read_b64_tr_b16 v[198:199], v63 offset:7200
    v_mfma_f32_16x16x32_bf16 v[120:123], v[168:171], v[224:227], v[120:123]
    ds_read_b64_tr_b16 v[200:201], v62 offset:7232
    ds_read_b64_tr_b16 v[202:203], v63 offset:7232
    v_mfma_f32_16x16x32_bf16 v[124:127], v[172:175], v[220:223], v[124:127]
    ds_read_b64_tr_b16 v[204:205], v62 offset:7264
    ds_read_b64_tr_b16 v[206:207], v63 offset:7264
    v_mfma_f32_16x16x32_bf16 v[128:131], v[172:175], v[224:227], v[128:131]
    ds_read_b64_tr_b16 v[208:209], v62 offset:7296
    ds_read_b64_tr_b16 v[210:211], v63 offset:7296
    s_waitcnt lgkmcnt(15)
    v_mfma_f32_16x16x32_bf16 v[132:135], v[176:179], v[220:223], v[132:135]
    ds_read_b64_tr_b16 v[212:213], v62 offset:7328
    v_mfma_f32_16x16x32_bf16 v[136:139], v[176:179], v[224:227], v[136:139]
    ds_read_b64_tr_b16 v[214:215], v63 offset:7328
    v_mfma_f32_16x16x32_bf16 v[140:143], v[180:183], v[220:223], v[140:143]
    ds_read_b64_tr_b16 v[216:217], v62 offset:7360
    v_mfma_f32_16x16x32_bf16 v[144:147], v[180:183], v[224:227], v[144:147]
    ds_read_b64_tr_b16 v[218:219], v63 offset:7360
    v_mfma_f32_16x16x32_bf16 v[148:151], v[184:187], v[220:223], v[148:151]
    ds_read_b64_tr_b16 v[76:77], v66 offset:7168
    v_mfma_f32_16x16x32_bf16 v[152:155], v[184:187], v[224:227], v[152:155]
    ds_read_b64_tr_b16 v[78:79], v67 offset:7168
    v_mfma_f32_16x16x32_bf16 v[156:159], v[188:191], v[220:223], v[156:159]
    ds_read_b64_tr_b16 v[80:81], v66 offset:7296
    v_mfma_f32_16x16x32_bf16 v[160:163], v[188:191], v[224:227], v[160:163]
    ds_read_b64_tr_b16 v[82:83], v67 offset:7296
    s_waitcnt lgkmcnt(15)
    v_mfma_f32_16x16x32_bf16 v[44:47], v[68:71], a[224:227], v[44:47]
    v_mfma_f32_16x16x32_bf16 v[48:51], v[72:75], a[224:227], v[48:51]
    s_waitcnt lgkmcnt(0)
    s_waitcnt vmcnt(6)
    s_waitcnt vmcnt(2)
    s_mov_b32 s67, 0
    s_cmp_lg_u32 s68, 0
    s_cbranch_scc1 L_pk_A
L_pl_A:
    v_cmp_le_u32 vcc, 32, v13
    s_nop 1
    s_and_b32 s75, vcc_lo, 63
    s_cmp_eq_u32 s75, 63
    s_cbranch_scc1 L_pk_A
    s_sleep 4
    s_mov_b64 exec, 63
    global_load_dword v13, v12, s[26:27] sc1
    s_mov_b64 exec, -1
    s_waitcnt vmcnt(0)
    s_add_u32 s67, s67, 1
    s_cmp_lt_u32 s67, 0x40000
    s_cbranch_scc1 L_pl_A
L_pk_A:
    s_barrier
    v_mfma_f32_16x16x32_bf16 v[108:111], v[192:195], v[228:231], v[108:111]
    ds_read_b128 v[220:223], v58 offset:30720
    ds_read_b128 v[224:227], v58 offset:32768
    v_mfma_f32_16x16x32_bf16 v[112:115], v[192:195], v[232:235], v[112:115]
    buffer_load_dwordx4 a[0:3], v3, s[48:51], s90 offen offset:0 sc1
    ds_read_b64_tr_b16 v[164:165], v62 offset:30720
    ds_read_b64_tr_b16 v[166:167], v63 offset:30720
    v_mfma_f32_16x16x32_bf16 v[116:119], v[196:199], v[228:231], v[116:119]
    ds_read_b64_tr_b16 v[168:169], v62 offset:30752
    ds_read_b64_tr_b16 v[170:171], v63 offset:30752
    v_mfma_f32_16x16x32_bf16 v[120:123], v[196:199], v[232:235], v[120:123]
    v_and_b32 v12, 15, v1
    v_lshlrev_b32 v12, 3, v12
    s_lshl_b32 s74, s71, 10
    s_lshl_b32 s75, s68, 8
    s_add_u32 s74, s74, s75
    s_add_u32 s74, s74, 11534336
    buffer_load_dwordx2 v[20:21], v12, s[48:51], s74 offen offset:0 sc1
    buffer_load_dwordx2 v[22:23], v12, s[48:51], s74 offen offset:128 sc1
    ds_read_b64_tr_b16 v[172:173], v62 offset:30784
    ds_read_b64_tr_b16 v[174:175], v63 offset:30784
    v_mfma_f32_16x16x32_bf16 v[124:127], v[200:203], v[228:231], v[124:127]
    buffer_load_dwordx4 a[4:7], v3, s[48:51], s90 offen offset:1024 sc1
    ds_read_b64_tr_b16 v[176:177], v62 offset:30816
    ds_read_b64_tr_b16 v[178:179], v63 offset:30816
    v_mfma_f32_16x16x32_bf16 v[128:131], v[200:203], v[232:235], v[128:131]
    ds_read_b64_tr_b16 v[180:181], v62 offset:30848
    ds_read_b64_tr_b16 v[182:183], v63 offset:30848
    v_mfma_f32_16x16x32_bf16 v[132:135], v[204:207], v[228:231], v[132:135]
    s_lshl_b32 s74, s69, 18
    s_lshl_b32 s75, s70, 13
    s_add_u32 s74, s74, s75
    s_add_u32 s75, s74, 4096
    v_lshlrev_b32 v24, 4, v0
    buffer_load_dwordx4 v[12:15], v24, s[48:51], s74 offen sc1
    buffer_load_dwordx4 v[16:19], v24, s[48:51], s75 offen sc1
    ds_read_b64_tr_b16 v[184:185], v62 offset:30880
    v_mfma_f32_16x16x32_bf16 v[136:139], v[204:207], v[232:235], v[136:139]
    buffer_load_dwordx4 a[8:11], v3, s[48:51], s90 offen offset:2048 sc1
    ds_read_b64_tr_b16 v[186:187], v63 offset:30880
    v_mfma_f32_16x16x32_bf16 v[140:143], v[208:211], v[228:231], v[140:143]
    ds_read_b64_tr_b16 v[188:189], v62 offset:30912
    v_mfma_f32_16x16x32_bf16 v[144:147], v[208:211], v[232:235], v[144:147]
    ds_read_b64_tr_b16 v[190:191], v63 offset:30912
    v_mfma_f32_16x16x32_bf16 v[148:151], v[212:215], v[228:231], v[148:151]
    buffer_load_dwordx4 a[12:15], v3, s[48:51], s90 offen offset:3072 sc1
    s_add_u32 s90, s90, 4096
    ds_read_b64_tr_b16 v[68:69], v66 offset:30720
    v_mfma_f32_16x16x32_bf16 v[152:155], v[212:215], v[232:235], v[152:155]
    ds_read_b64_tr_b16 v[70:71], v67 offset:30720
    v_mfma_f32_16x16x32_bf16 v[156:159], v[216:219], v[228:231], v[156:159]
    ds_read_b64_tr_b16 v[72:73], v66 offset:30848
    v_mfma_f32_16x16x32_bf16 v[160:163], v[216:219], v[232:235], v[160:163]
    ds_read_b64_tr_b16 v[74:75], v67 offset:30848
    v_mfma_f32_16x16x32_bf16 v[44:47], v[76:79], a[224:227], v[44:47]
    v_mfma_f32_16x16x32_bf16 v[48:51], v[80:83], a[224:227], v[48:51]
    s_waitcnt lgkmcnt(15)
    v_mfma_f32_16x16x32_bf16 v[108:111], v[164:167], v[220:223], v[108:111]
    ds_read_b128 v[228:231], v59 offset:30720
    ds_read_b128 v[232:235], v59 offset:32768
    v_mfma_f32_16x16x32_bf16 v[112:115], v[164:167], v[224:227], v[112:115]
    buffer_load_dwordx4 a[16:19], v3, s[48:51], s90 offen offset:0 sc1
    ds_read_b64_tr_b16 v[192:193], v62 offset:37888
    ds_read_b64_tr_b16 v[194:195], v63 offset:37888
    s_waitcnt lgkmcnt(15)
    v_mfma_f32_16x16x32_bf16 v[116:119], v[168:171], v[220:223], v[116:119]
    ds_read_b64_tr_b16 v[196:197], v62 offset:37920
    ds_read_b64_tr_b16 v[198:199], v63 offset:37920
    v_mfma_f32_16x16x32_bf16 v[120:123], v[168:171], v[224:227], v[120:123]
    ds_read_b64_tr_b16 v[200:201], v62 offset:37952
    ds_read_b64_tr_b16 v[202:203], v63 offset:37952
    v_mfma_f32_16x16x32_bf16 v[124:127], v[172:175], v[220:223], v[124:127]
    buffer_load_dwordx4 a[20:23], v3, s[48:51], s90 offen offset:1024 sc1
    ds_read_b64_tr_b16 v[204:205], v62 offset:37984
    ds_read_b64_tr_b16 v[206:207], v63 offset:37984
    v_mfma_f32_16x16x32_bf16 v[128:131], v[172:175], v[224:227], v[128:131]
    ds_read_b64_tr_b16 v[208:209], v62 offset:38016
    ds_read_b64_tr_b16 v[210:211], v63 offset:38016
    s_waitcnt lgkmcnt(15)
    v_mfma_f32_16x16x32_bf16 v[132:135], v[176:179], v[220:223], v[132:135]
    ds_read_b64_tr_b16 v[212:213], v62 offset:38048
    v_mfma_f32_16x16x32_bf16 v[136:139], v[176:179], v[224:227], v[136:139]
    buffer_load_dwordx4 a[24:27], v3, s[48:51], s90 offen offset:2048 sc1
    ds_read_b64_tr_b16 v[214:215], v63 offset:38048
    v_mfma_f32_16x16x32_bf16 v[140:143], v[180:183], v[220:223], v[140:143]
    ds_read_b64_tr_b16 v[216:217], v62 offset:38080
    v_mfma_f32_16x16x32_bf16 v[144:147], v[180:183], v[224:227], v[144:147]
    ds_read_b64_tr_b16 v[218:219], v63 offset:38080
    v_mfma_f32_16x16x32_bf16 v[148:151], v[184:187], v[220:223], v[148:151]
    buffer_load_dwordx4 a[28:31], v3, s[48:51], s90 offen offset:3072 sc1
    s_add_u32 s90, s90, 4096
    ds_read_b64_tr_b16 v[76:77], v66 offset:37888
    v_mfma_f32_16x16x32_bf16 v[152:155], v[184:187], v[224:227], v[152:155]
    ds_read_b64_tr_b16 v[78:79], v67 offset:37888
    v_mfma_f32_16x16x32_bf16 v[156:159], v[188:191], v[220:223], v[156:159]
    ds_read_b64_tr_b16 v[80:81], v66 offset:38016
    v_mfma_f32_16x16x32_bf16 v[160:163], v[188:191], v[224:227], v[160:163]
    ds_read_b64_tr_b16 v[82:83], v67 offset:38016
    s_waitcnt lgkmcnt(15)
    v_mfma_f32_16x16x32_bf16 v[44:47], v[68:71], a[224:227], v[44:47]
    v_mfma_f32_16x16x32_bf16 v[48:51], v[72:75], a[224:227], v[48:51]
    v_mfma_f32_16x16x32_bf16 v[108:111], v[192:195], v[228:231], v[108:111]
    v_mfma_f32_16x16x32_bf16 v[112:115], v[192:195], v[232:235], v[112:115]
    buffer_load_dwordx4 a[32:35], v3, s[48:51], s90 offen offset:0 sc1
    s_waitcnt lgkmcnt(14)
    v_mfma_f32_16x16x32_bf16 v[116:119], v[196:199], v[228:231], v[116:119]
    v_mfma_f32_16x16x32_bf16 v[120:123], v[196:199], v[232:235], v[120:123]
    s_waitcnt lgkmcnt(12)
    v_mfma_f32_16x16x32_bf16 v[124:127], v[200:203], v[228:231], v[124:127]
    buffer_load_dwordx4 a[36:39], v3, s[48:51], s90 offen offset:1024 sc1
    v_mfma_f32_16x16x32_bf16 v[128:131], v[200:203], v[232:235], v[128:131]
    s_waitcnt lgkmcnt(10)
    v_mfma_f32_16x16x32_bf16 v[132:135], v[204:207], v[228:231], v[132:135]
    v_mfma_f32_16x16x32_bf16 v[136:139], v[204:207], v[232:235], v[136:139]
    buffer_load_dwordx4 a[40:43], v3, s[48:51], s90 offen offset:2048 sc1
    s_waitcnt lgkmcnt(8)
    v_mfma_f32_16x16x32_bf16 v[140:143], v[208:211], v[228:231], v[140:143]
    v_mfma_f32_16x16x32_bf16 v[144:147], v[208:211], v[232:235], v[144:147]
    s_waitcnt lgkmcnt(6)
    v_mfma_f32_16x16x32_bf16 v[148:151], v[212:215], v[228:231], v[148:151]
    buffer_load_dwordx4 a[44:47], v3, s[48:51], s90 offen offset:3072 sc1
    s_add_u32 s90, s90, 4096
    v_mfma_f32_16x16x32_bf16 v[152:155], v[212:215], v[232:235], v[152:155]
    s_waitcnt lgkmcnt(4)
    v_mfma_f32_16x16x32_bf16 v[156:159], v[216:219], v[228:231], v[156:159]
    v_mfma_f32_16x16x32_bf16 v[160:163], v[216:219], v[232:235], v[160:163]
    s_waitcnt lgkmcnt(2)
    v_mfma_f32_16x16x32_bf16 v[44:47], v[76:79], a[224:227], v[44:47]
    s_waitcnt lgkmcnt(0)
    v_mfma_f32_16x16x32_bf16 v[48:51], v[80:83], a[224:227], v[48:51]
    s_waitcnt lgkmcnt(0)
    v_lshrrev_b32 v24, 4, v1
    v_lshlrev_b32 v24, 4, v24
    s_lshl_b32 s74, s68, 6
    s_add_u32 s74, s74, 158208
    v_add_u32 v25, s74, v24
    v_and_b32 v26, 15, v1
    v_cmp_eq_u32 vcc, 0, v26
    s_nop 0
    s_mov_b64 exec, vcc
    ds_write_b128 v25, v[44:47]
    ds_write_b128 v25, v[48:51] offset:256
    s_mov_b64 exec, -1
    buffer_load_dwordx4 a[48:51], v3, s[48:51], s90 offen offset:0 sc1
    buffer_load_dwordx4 a[52:55], v3, s[48:51], s90 offen offset:1024 sc1
    buffer_load_dwordx4 a[56:59], v3, s[48:51], s90 offen offset:2048 sc1
    buffer_load_dwordx4 a[60:63], v3, s[48:51], s90 offen offset:3072 sc1
    s_add_u32 s90, s90, 4096
    s_waitcnt lgkmcnt(0)
    s_barrier
    v_add_u32 v25, 158208, v24
    ds_read_b128 v[52:55], v25 offset:0
    ds_read_b128 v[56:59], v25 offset:64
    ds_read_b128 v[60:63], v25 offset:128
    ds_read_b128 v[64:67], v25 offset:192
    ds_read_b128 v[68:71], v25 offset:256
    ds_read_b128 v[72:75], v25 offset:320
    ds_read_b128 v[76:79], v25 offset:384
    v_mov_b32 v8, 0
    v_mov_b32 v9, 0
    v_mov_b32 v10, 0
    v_mov_b32 v11, 0
    v_lshlrev_b32 v32, 4, v0
    v_add_u32 v32, 5120, v32
    v_cmp_gt_u32 vcc, 155, v0
    s_nop 0
    s_and_saveexec_b64 s[82:83], vcc
    ds_write_b128 v32, v[8:11]
    ds_write_b128 v32, v[8:11] offset:7600
    s_mov_b64 exec, s[82:83]
    s_mov_b32 s85, 0xbfb8aa3b
    v_mov_b32 v34, s85
    v_mov_b32 v35, s85
    s_waitcnt vmcnt(17)
    v_sub_f32 v36, 0, v20
    v_sub_f32 v37, 0, v20
    v_mul_f32 v40, s85, v21
    v_mul_f32 v41, s85, v21
    v_sub_f32 v38, 0, v22
    v_sub_f32 v39, 0, v22
    v_mul_f32 v42, s85, v23
    v_mul_f32 v43, s85, v23
    s_lshr_b32 s74, s68, 1
    s_lshl_b32 s75, s71, 1
    s_add_u32 s74, s74, s75
    s_mul_i32 s74, s74, 229376
    s_add_u32 s74, s74, 4194304
    s_and_b32 s75, s68, 1
    s_lshl_b32 s75, s75, 11
    s_add_u32 s74, s74, s75
    s_lshr_b32 s75, s72, 1
    s_mul_i32 s75, s75, 28672
    s_add_u32 s74, s74, s75
    s_and_b32 s75, s72, 1
    s_mul_i32 s64, s75, 12288
    s_add_u32 s86, s74, s64
    s_lshl_b32 s64, s75, 9
    s_add_u32 s87, s74, s64
    s_add_u32 s87, s87, 24576
    v_and_b32 v8, 15, v1
    v_lshlrev_b32 v8, 4, v8
    v_lshrrev_b32 v24, 5, v1
    v_lshl_add_u32 v8, v24, 8, v8
    s_waitcnt lgkmcnt(2)
    v_pk_fma_f32 v[100:101], v[52:53], v[36:37], v[108:109]
    v_pk_fma_f32 v[102:103], v[54:55], v[36:37], v[110:111]
    v_pk_fma_f32 v[104:105], v[56:57], v[36:37], v[116:117]
    v_pk_fma_f32 v[106:107], v[58:59], v[36:37], v[118:119]
    v_pk_mul_f32 v[100:101], v[100:101], v[40:41]
    v_pk_mul_f32 v[102:103], v[102:103], v[40:41]
    v_pk_mul_f32 v[104:105], v[104:105], v[40:41]
    v_pk_mul_f32 v[106:107], v[106:107], v[40:41]
    v_exp_f32 v164, v100
    v_exp_f32 v165, v101
    v_exp_f32 v166, v102
    v_exp_f32 v167, v103
    v_exp_f32 v168, v104
    v_exp_f32 v169, v105
    v_exp_f32 v170, v106
    v_exp_f32 v171, v107
    v_lshlrev_b32 v10, 4, v0
    v_add_u32 v10, 122944, v10
    v_and_b32 v180, 3, v1
    v_lshrrev_b32 v181, 2, v1
    v_mul_u32_u24 v181, 16640, v181
    v_lshl_add_u32 v180, v180, 4, v181
    v_add_u32 v11, 122880, v180
    v_pk_fma_f32 v[164:165], v[164:165], v[34:35], v[34:35]
    v_pk_fma_f32 v[166:167], v[166:167], v[34:35], v[34:35]
    v_pk_fma_f32 v[168:169], v[168:169], v[34:35], v[34:35]
    v_pk_fma_f32 v[170:171], v[170:171], v[34:35], v[34:35]
    v_rcp_f32 v164, v164
    v_rcp_f32 v165, v165
    v_rcp_f32 v166, v166
    v_rcp_f32 v167, v167
    v_rcp_f32 v168, v168
    v_rcp_f32 v169, v169
    v_rcp_f32 v170, v170
    v_rcp_f32 v171, v171
    v_pk_mul_f32 v[100:101], v[100:101], v[164:165]
    v_pk_mul_f32 v[102:103], v[102:103], v[166:167]
    v_pk_mul_f32 v[104:105], v[104:105], v[168:169]
    v_pk_mul_f32 v[106:107], v[106:107], v[170:171]
    ds_write_b128 v10, v[86:89] offset:12480
    v_cvt_pk_bf16_f32 v172, v100, v101
    v_cvt_pk_bf16_f32 v173, v102, v103
    v_cvt_pk_bf16_f32 v174, v104, v105
    v_cvt_pk_bf16_f32 v175, v106, v107
    s_add_u32 s74, s86, 0
    buffer_store_dwordx4 v[172:175], v3, s[48:51], s74 offen offset:0 sc1
    v_pk_fma_f32 v[100:101], v[52:53], v[38:39], v[112:113]
    v_pk_fma_f32 v[102:103], v[54:55], v[38:39], v[114:115]
    v_pk_fma_f32 v[104:105], v[56:57], v[38:39], v[120:121]
    v_pk_fma_f32 v[106:107], v[58:59], v[38:39], v[122:123]
    v_pk_mul_f32 v[100:101], v[100:101], v[42:43]
    v_pk_mul_f32 v[102:103], v[102:103], v[42:43]
    v_pk_mul_f32 v[104:105], v[104:105], v[42:43]
    v_pk_mul_f32 v[106:107], v[106:107], v[42:43]
    v_exp_f32 v164, v100
    v_exp_f32 v165, v101
    v_exp_f32 v166, v102
    v_exp_f32 v167, v103
    v_alignbit_b32 v180, v85, v84, 16
    v_alignbit_b32 v181, v86, v85, 16
    v_alignbit_b32 v182, v87, v86, 16
    v_alignbit_b32 v183, v88, v87, 16
    ds_write_b128 v10, v[180:183] offset:0
    v_exp_f32 v168, v104
    v_exp_f32 v169, v105
    v_exp_f32 v170, v106
    v_exp_f32 v171, v107
    v_pk_fma_f32 v[164:165], v[164:165], v[34:35], v[34:35]
    v_pk_fma_f32 v[166:167], v[166:167], v[34:35], v[34:35]
    v_pk_fma_f32 v[168:169], v[168:169], v[34:35], v[34:35]
    v_pk_fma_f32 v[170:171], v[170:171], v[34:35], v[34:35]
    v_rcp_f32 v164, v164
    v_rcp_f32 v165, v165
    v_rcp_f32 v166, v166
    v_rcp_f32 v167, v167
    v_rcp_f32 v168, v168
    v_rcp_f32 v169, v169
    v_rcp_f32 v170, v170
    v_rcp_f32 v171, v171
    v_alignbit_b32 v184, v86, v85, 16
    v_alignbit_b32 v185, v87, v86, 16
    v_alignbit_b32 v186, v88, v87, 16
    v_alignbit_b32 v187, v89, v88, 16
    ds_write_b128 v10, v[184:187] offset:8320
    v_pk_mul_f32 v[100:101], v[100:101], v[164:165]
    v_pk_mul_f32 v[102:103], v[102:103], v[166:167]
    v_pk_mul_f32 v[104:105], v[104:105], v[168:169]
    v_pk_mul_f32 v[106:107], v[106:107], v[170:171]
    v_cvt_pk_bf16_f32 v176, v100, v101
    v_cvt_pk_bf16_f32 v177, v102, v103
    v_cvt_pk_bf16_f32 v178, v104, v105
    v_cvt_pk_bf16_f32 v179, v106, v107
    s_add_u32 s74, s86, 0
    buffer_store_dwordx4 v[176:179], v3, s[48:51], s74 offen offset:1024 sc1
    v_pk_fma_f32 v[100:101], v[60:61], v[36:37], v[124:125]
    v_pk_fma_f32 v[102:103], v[62:63], v[36:37], v[126:127]
    v_pk_fma_f32 v[104:105], v[64:65], v[36:37], v[132:133]
    v_pk_fma_f32 v[106:107], v[66:67], v[36:37], v[134:135]
    v_pk_mul_f32 v[100:101], v[100:101], v[40:41]
    v_pk_mul_f32 v[102:103], v[102:103], v[40:41]
    v_pk_mul_f32 v[104:105], v[104:105], v[40:41]
    v_pk_mul_f32 v[106:107], v[106:107], v[40:41]
    v_mov_b32 v188, v85
    v_mov_b32 v189, v86
    v_mov_b32 v190, v87
    v_mov_b32 v191, v88
    ds_write_b128 v10, v[188:191] offset:4160
    v_exp_f32 v164, v100
    v_exp_f32 v165, v101
    v_exp_f32 v166, v102
    v_exp_f32 v167, v103
    v_exp_f32 v168, v104
    v_exp_f32 v169, v105
    v_exp_f32 v170, v106
    v_exp_f32 v171, v107
    v_pk_fma_f32 v[164:165], v[164:165], v[34:35], v[34:35]
    v_pk_fma_f32 v[166:167], v[166:167], v[34:35], v[34:35]
    v_pk_fma_f32 v[168:169], v[168:169], v[34:35], v[34:35]
    v_pk_fma_f32 v[170:171], v[170:171], v[34:35], v[34:35]
    v_rcp_f32 v164, v164
    v_rcp_f32 v165, v165
    v_rcp_f32 v166, v166
    v_rcp_f32 v167, v167
    ds_write_b128 v10, v[94:97] offset:29120
    v_rcp_f32 v168, v168
    v_rcp_f32 v169, v169
    v_rcp_f32 v170, v170
    v_rcp_f32 v171, v171
    v_pk_mul_f32 v[100:101], v[100:101], v[164:165]
    v_pk_mul_f32 v[102:103], v[102:103], v[166:167]
    v_pk_mul_f32 v[104:105], v[104:105], v[168:169]
    v_pk_mul_f32 v[106:107], v[106:107], v[170:171]
    v_cvt_pk_bf16_f32 v172, v100, v101
    v_cvt_pk_bf16_f32 v173, v102, v103
    v_cvt_pk_bf16_f32 v174, v104, v105
    v_cvt_pk_bf16_f32 v175, v106, v107
    s_add_u32 s74, s86, 4096
    buffer_store_dwordx4 v[172:175], v3, s[48:51], s74 offen offset:0 sc1
    v_pk_fma_f32 v[100:101], v[60:61], v[38:39], v[128:129]
    v_pk_fma_f32 v[102:103], v[62:63], v[38:39], v[130:131]
    v_pk_fma_f32 v[104:105], v[64:65], v[38:39], v[136:137]
    v_pk_fma_f32 v[106:107], v[66:67], v[38:39], v[138:139]
    v_alignbit_b32 v180, v93, v92, 16
    v_alignbit_b32 v181, v94, v93, 16
    v_alignbit_b32 v182, v95, v94, 16
    v_alignbit_b32 v183, v96, v95, 16
    ds_write_b128 v10, v[180:183] offset:16640
    v_pk_mul_f32 v[100:101], v[100:101], v[42:43]
    v_pk_mul_f32 v[102:103], v[102:103], v[42:43]
    v_pk_mul_f32 v[104:105], v[104:105], v[42:43]
    v_pk_mul_f32 v[106:107], v[106:107], v[42:43]
    v_exp_f32 v164, v100
    v_exp_f32 v165, v101
    v_exp_f32 v166, v102
    v_exp_f32 v167, v103
    v_exp_f32 v168, v104
    v_exp_f32 v169, v105
    v_exp_f32 v170, v106
    v_exp_f32 v171, v107
    v_pk_fma_f32 v[164:165], v[164:165], v[34:35], v[34:35]
    v_pk_fma_f32 v[166:167], v[166:167], v[34:35], v[34:35]
    v_pk_fma_f32 v[168:169], v[168:169], v[34:35], v[34:35]
    v_pk_fma_f32 v[170:171], v[170:171], v[34:35], v[34:35]
    v_alignbit_b32 v184, v94, v93, 16
    v_alignbit_b32 v185, v95, v94, 16
    v_alignbit_b32 v186, v96, v95, 16
    v_alignbit_b32 v187, v97, v96, 16
    ds_write_b128 v10, v[184:187] offset:24960
    v_rcp_f32 v164, v164
    v_rcp_f32 v165, v165
    v_rcp_f32 v166, v166
    v_rcp_f32 v167, v167
    v_rcp_f32 v168, v168
    v_rcp_f32 v169, v169
    v_rcp_f32 v170, v170
    v_rcp_f32 v171, v171
    v_pk_mul_f32 v[100:101], v[100:101], v[164:165]
    v_pk_mul_f32 v[102:103], v[102:103], v[166:167]
    v_pk_mul_f32 v[104:105], v[104:105], v[168:169]
    v_pk_mul_f32 v[106:107], v[106:107], v[170:171]
    v_cvt_pk_bf16_f32 v176, v100, v101
    v_cvt_pk_bf16_f32 v177, v102, v103
    v_cvt_pk_bf16_f32 v178, v104, v105
    v_cvt_pk_bf16_f32 v179, v106, v107
    v_mov_b32 v188, v93
    v_mov_b32 v189, v94
    v_mov_b32 v190, v95
    v_mov_b32 v191, v96
    ds_write_b128 v10, v[188:191] offset:20800
    s_add_u32 s74, s86, 4096
    buffer_store_dwordx4 v[176:179], v3, s[48:51], s74 offen offset:1024 sc1
    v_pk_fma_f32 v[100:101], v[68:69], v[36:37], v[140:141]
    v_pk_fma_f32 v[102:103], v[70:71], v[36:37], v[142:143]
    v_pk_fma_f32 v[104:105], v[72:73], v[36:37], v[148:149]
    v_pk_fma_f32 v[106:107], v[74:75], v[36:37], v[150:151]
    v_pk_mul_f32 v[100:101], v[100:101], v[40:41]
    v_pk_mul_f32 v[102:103], v[102:103], v[40:41]
    v_pk_mul_f32 v[104:105], v[104:105], v[40:41]
    v_pk_mul_f32 v[106:107], v[106:107], v[40:41]
    v_exp_f32 v164, v100
    v_exp_f32 v165, v101
    v_exp_f32 v166, v102
    v_exp_f32 v167, v103
    v_exp_f32 v168, v104
    v_exp_f32 v169, v105
    v_exp_f32 v170, v106
    v_exp_f32 v171, v107
    v_cmp_gt_u32 vcc, 8, v0
    s_nop 0
    s_and_saveexec_b64 s[82:83], vcc
    s_cbranch_execz L_hx_skip
    v_mov_b32 v84, 0
    v_mov_b32 v85, 0
    v_mov_b32 v86, 0
    v_mov_b32 v87, 0
    v_mov_b32 v88, v6
    v_mov_b32 v89, v7
    ds_write_b128 v11, v[86:89] offset:12480
    v_alignbit_b32 v180, v85, v84, 16
    v_alignbit_b32 v181, v86, v85, 16
    v_alignbit_b32 v182, v87, v86, 16
    v_alignbit_b32 v183, v88, v87, 16
    ds_write_b128 v11, v[180:183] offset:0
    v_alignbit_b32 v184, v86, v85, 16
    v_alignbit_b32 v185, v87, v86, 16
    v_alignbit_b32 v186, v88, v87, 16
    v_alignbit_b32 v187, v89, v88, 16
    ds_write_b128 v11, v[184:187] offset:8320
    v_mov_b32 v188, v85
    v_mov_b32 v189, v86
    v_mov_b32 v190, v87
    v_mov_b32 v191, v88
    ds_write_b128 v11, v[188:191] offset:4160
L_hx_skip:
    s_mov_b64 exec, s[82:83]
    v_pk_fma_f32 v[164:165], v[164:165], v[34:35], v[34:35]
    v_pk_fma_f32 v[166:167], v[166:167], v[34:35], v[34:35]
    v_pk_fma_f32 v[168:169], v[168:169], v[34:35], v[34:35]
    v_pk_fma_f32 v[170:171], v[170:171], v[34:35], v[34:35]
    v_rcp_f32 v164, v164
    v_rcp_f32 v165, v165
    v_rcp_f32 v166, v166
    v_rcp_f32 v167, v167
    v_rcp_f32 v168, v168
    v_rcp_f32 v169, v169
    v_rcp_f32 v170, v170
    v_rcp_f32 v171, v171
    v_pk_mul_f32 v[100:101], v[100:101], v[164:165]
    v_pk_mul_f32 v[102:103], v[102:103], v[166:167]
    v_pk_mul_f32 v[104:105], v[104:105], v[168:169]
    v_pk_mul_f32 v[106:107], v[106:107], v[170:171]
    v_cvt_pk_bf16_f32 v172, v100, v101
    v_cvt_pk_bf16_f32 v173, v102, v103
    v_cvt_pk_bf16_f32 v174, v104, v105
    v_cvt_pk_bf16_f32 v175, v106, v107
    s_add_u32 s74, s86, 8192
    buffer_store_dwordx4 v[172:175], v3, s[48:51], s74 offen offset:0 sc1
    v_pk_fma_f32 v[100:101], v[68:69], v[38:39], v[144:145]
    v_pk_fma_f32 v[102:103], v[70:71], v[38:39], v[146:147]
    v_pk_fma_f32 v[104:105], v[72:73], v[38:39], v[152:153]
    v_pk_fma_f32 v[106:107], v[74:75], v[38:39], v[154:155]
    v_pk_mul_f32 v[100:101], v[100:101], v[42:43]
    v_pk_mul_f32 v[102:103], v[102:103], v[42:43]
    v_pk_mul_f32 v[104:105], v[104:105], v[42:43]
    v_pk_mul_f32 v[106:107], v[106:107], v[42:43]
    v_exp_f32 v164, v100
    v_exp_f32 v165, v101
    v_exp_f32 v166, v102
    v_exp_f32 v167, v103
    v_exp_f32 v168, v104
    v_exp_f32 v169, v105
    v_exp_f32 v170, v106
    v_exp_f32 v171, v107
    v_pk_fma_f32 v[164:165], v[164:165], v[34:35], v[34:35]
    v_pk_fma_f32 v[166:167], v[166:167], v[34:35], v[34:35]
    v_pk_fma_f32 v[168:169], v[168:169], v[34:35], v[34:35]
    v_pk_fma_f32 v[170:171], v[170:171], v[34:35], v[34:35]
    v_rcp_f32 v164, v164
    v_rcp_f32 v165, v165
    v_rcp_f32 v166, v166
    v_rcp_f32 v167, v167
    v_rcp_f32 v168, v168
    v_rcp_f32 v169, v169
    v_rcp_f32 v170, v170
    v_rcp_f32 v171, v171
    v_pk_mul_f32 v[100:101], v[100:101], v[164:165]
    v_pk_mul_f32 v[102:103], v[102:103], v[166:167]
    v_pk_mul_f32 v[104:105], v[104:105], v[168:169]
    v_pk_mul_f32 v[106:107], v[106:107], v[170:171]
    v_cvt_pk_bf16_f32 v176, v100, v101
    v_cvt_pk_bf16_f32 v177, v102, v103
    v_cvt_pk_bf16_f32 v178, v104, v105
    v_cvt_pk_bf16_f32 v179, v106, v107
    s_add_u32 s74, s86, 8192
    buffer_store_dwordx4 v[176:179], v3, s[48:51], s74 offen offset:1024 sc1
    v_pk_fma_f32 v[100:101], v[76:77], v[36:37], v[156:157]
    v_pk_fma_f32 v[102:103], v[78:79], v[36:37], v[158:159]
    v_pk_mul_f32 v[100:101], v[100:101], v[40:41]
    v_pk_mul_f32 v[102:103], v[102:103], v[40:41]
    v_exp_f32 v164, v100
    v_exp_f32 v165, v101
    v_exp_f32 v166, v102
    v_exp_f32 v167, v103
    v_pk_fma_f32 v[164:165], v[164:165], v[34:35], v[34:35]
    v_pk_fma_f32 v[166:167], v[166:167], v[34:35], v[34:35]
    v_rcp_f32 v164, v164
    v_rcp_f32 v165, v165
    v_rcp_f32 v166, v166
    v_rcp_f32 v167, v167
    v_pk_mul_f32 v[100:101], v[100:101], v[164:165]
    v_pk_mul_f32 v[102:103], v[102:103], v[166:167]
    v_cvt_pk_bf16_f32 v172, v100, v101
    v_cvt_pk_bf16_f32 v173, v102, v103
    v_mov_b32 v174, v172
    v_mov_b32 v175, v173
    s_nop 0
    v_permlane16_swap_b32 v172, v174
    v_permlane16_swap_b32 v173, v175
    s_mov_b32 s82, 0xffff
    s_mov_b32 s83, 0xffff
    s_mov_b64 exec, s[82:83]
    buffer_store_dwordx4 v[172:175], v8, s[48:51], s87 offen offset:0 sc1
    s_mov_b64 exec, -1
    v_pk_fma_f32 v[100:101], v[76:77], v[38:39], v[160:161]
    v_pk_fma_f32 v[102:103], v[78:79], v[38:39], v[162:163]
    v_pk_mul_f32 v[100:101], v[100:101], v[42:43]
    v_pk_mul_f32 v[102:103], v[102:103], v[42:43]
    v_exp_f32 v164, v100
    v_exp_f32 v165, v101
    v_exp_f32 v166, v102
    v_exp_f32 v167, v103
    v_pk_fma_f32 v[164:165], v[164:165], v[34:35], v[34:35]
    v_pk_fma_f32 v[166:167], v[166:167], v[34:35], v[34:35]
    v_rcp_f32 v164, v164
    v_rcp_f32 v165, v165
    v_rcp_f32 v166, v166
    v_rcp_f32 v167, v167
    v_pk_mul_f32 v[100:101], v[100:101], v[164:165]
    v_pk_mul_f32 v[102:103], v[102:103], v[166:167]
    v_cvt_pk_bf16_f32 v176, v100, v101
    v_cvt_pk_bf16_f32 v177, v102, v103
    v_mov_b32 v178, v176
    v_mov_b32 v179, v177
    s_nop 0
    v_permlane16_swap_b32 v176, v178
    v_permlane16_swap_b32 v177, v179
    s_mov_b32 s82, 0xffff
    s_mov_b32 s83, 0xffff
    s_mov_b64 exec, s[82:83]
    buffer_store_dwordx4 v[176:179], v8, s[48:51], s87 offen offset:1024 sc1
    s_mov_b64 exec, -1
    s_lshr_b32 s18, s68, 1
    s_and_b32 s19, s68, 1
    v_and_b32 v251, 3, v1
    v_mul_u32_u24 v251, 4160, v251
    v_bfe_u32 v252, v1, 2, 3
    v_lshl_add_u32 v251, v252, 3, v251
    v_lshrrev_b32 v252, 5, v1
    v_lshl_add_u32 v251, v252, 4, v251
    s_mul_i32 s74, s18, 16640
    s_lshl_b32 s75, s19, 10
    s_add_u32 s74, s74, s75
    s_add_u32 s74, s74, 122880
    v_add_u32 v239, s74, v251
    v_and_b32 v251, 31, v1
    v_sub_u32 v251, 63, v251
    v_mul_u32_u24 v251, 80, v251
    s_mul_i32 s74, s18, 7600
    v_add_u32 v251, s74, v251
    s_mul_i32 s75, s19, 2560
    v_lshlrev_b32 v253, 3, v252
    v_sub_u32 v253, 8, v253
    v_add_u32 v253, v253, v251
    v_subrev_u32 v238, s75, v253
    v_lshl_add_u32 v251, v252, 4, v251
    s_mul_i32 s75, s19, 1280
    v_add_u32 v240, s75, v251
    v_subrev_u32 v241, 2560, v240
    s_add_u32 s4, s91, 0
    s_add_u32 s5, s91, 4096
    s_add_u32 s6, s91, 8192
    s_add_u32 s7, s91, 12288
    s_add_u32 s8, s91, 16384
    s_add_u32 s9, s91, 20480
    s_add_u32 s10, s91, 24576
    s_add_u32 s11, s91, 28672
    s_add_u32 s12, s91, 32768
    s_add_u32 s13, s91, 36864
    s_add_u32 s14, s91, 40960
    s_add_u32 s15, s91, 45056
    s_add_u32 s16, s91, 49152
    s_add_u32 s17, s91, 53248
    s_add_u32 s74, s68, 0
    s_and_b32 s74, s74, 3
    s_lshl_b32 s74, s74, 10
    v_add_u32 v246, s74, v3
    v_lshrrev_b32 v242, 1, v3
    v_add_u32 v242, s74, v242
    s_add_u32 s74, s68, 1
    s_and_b32 s74, s74, 3
    s_lshl_b32 s74, s74, 10
    v_add_u32 v247, s74, v3
    v_lshrrev_b32 v243, 1, v3
    v_add_u32 v243, s74, v243
    s_add_u32 s74, s68, 2
    s_and_b32 s74, s74, 3
    s_lshl_b32 s74, s74, 10
    v_add_u32 v248, s74, v3
    v_lshrrev_b32 v244, 1, v3
    v_add_u32 v244, s74, v244
    s_add_u32 s74, s68, 3
    s_and_b32 s74, s74, 3
    s_lshl_b32 s74, s74, 10
    v_add_u32 v249, s74, v3
    v_lshrrev_b32 v245, 1, v3
    v_add_u32 v245, s74, v245
    v_lshrrev_b32 v250, 2, v0
    v_mul_u32_u24 v250, 80, v250
    v_and_b32 v254, 3, v0
    v_lshl_add_u32 v250, v254, 4, v250
    s_waitcnt vmcnt(22)
    ds_write_b128 v250, v[12:15]
    ds_write_b128 v250, v[16:19] offset:7600
    s_waitcnt lgkmcnt(0)
    s_barrier
    ds_read_b64 v[136:137], v239 offset:0
    ds_read_b64 v[138:139], v239 offset:8
    ds_read_b128 v[140:143], v240 offset:0
    ds_read_b128 v[144:147], v241 offset:0
    ds_read_b64 v[148:149], v239 offset:2048
    ds_read_b64 v[150:151], v239 offset:2056
    ds_read_b128 v[152:155], v241 offset:2560
    ds_read_b64 v[156:157], v239 offset:32
    ds_read_b64 v[158:159], v239 offset:40
    ds_read_b128 v[160:163], v240 offset:32
    ds_read_b128 v[164:167], v241 offset:32
    ds_read_b64 v[168:169], v239 offset:2080
    ds_read_b64 v[170:171], v239 offset:2088
    ds_read_b128 v[172:175], v241 offset:2592
    s_waitcnt lgkmcnt(7)
    v_mfma_f32_32x32x16_bf16 v[104:119], v[136:139], v[140:143], 0
    ds_read_b64 v[176:177], v239 offset:64
    ds_read_b64 v[178:179], v239 offset:72
    ds_read_b128 v[180:183], v240 offset:80
    v_mfma_f32_32x32x16_bf16 v[120:135], v[136:139], v[144:147], 0
    ds_read_b128 v[184:187], v241 offset:80
    ds_read_b64 v[188:189], v239 offset:2112
    v_mfma_f32_32x32x16_bf16 v[120:135], v[148:151], v[152:155], v[120:135]
    ds_read_b64 v[190:191], v239 offset:2120
    ds_read_b128 v[192:195], v241 offset:2640
    s_waitcnt lgkmcnt(7)
    v_mfma_f32_32x32x16_bf16 v[104:119], v[156:159], v[160:163], v[104:119]
    ds_read_b64 v[136:137], v239 offset:96
    ds_read_b64 v[138:139], v239 offset:104
    ds_read_b128 v[140:143], v240 offset:112
    buffer_load_dwordx4 a[64:67], v3, s[48:51], s90 offen offset:0 sc1
    v_mfma_f32_32x32x16_bf16 v[120:135], v[156:159], v[164:167], v[120:135]
    ds_read_b128 v[144:147], v241 offset:112
    ds_read_b64 v[148:149], v239 offset:2144
    v_mfma_f32_32x32x16_bf16 v[120:135], v[168:171], v[172:175], v[120:135]
    ds_read_b64 v[150:151], v239 offset:2152
    ds_read_b128 v[152:155], v241 offset:2672
    buffer_load_dwordx4 a[68:71], v3, s[48:51], s90 offen offset:1024 sc1
    s_waitcnt lgkmcnt(7)
    v_mfma_f32_32x32x16_bf16 v[104:119], v[176:179], v[180:183], v[104:119]
    ds_read_b64 v[156:157], v239 offset:128
    ds_read_b64 v[158:159], v239 offset:136
    ds_read_b128 v[160:163], v240 offset:160
    buffer_load_dwordx4 a[72:75], v3, s[48:51], s90 offen offset:2048 sc1
    v_mfma_f32_32x32x16_bf16 v[120:135], v[176:179], v[184:187], v[120:135]
    ds_read_b128 v[164:167], v241 offset:160
    ds_read_b64 v[168:169], v239 offset:2176
    v_mfma_f32_32x32x16_bf16 v[120:135], v[188:191], v[192:195], v[120:135]
    ds_read_b64 v[170:171], v239 offset:2184
    ds_read_b128 v[172:175], v241 offset:2720
    buffer_load_dwordx4 a[76:79], v3, s[48:51], s90 offen offset:3072 sc1
    s_add_u32 s90, s90, 4096
    s_waitcnt lgkmcnt(7)
    v_mfma_f32_32x32x16_bf16 v[104:119], v[136:139], v[140:143], v[104:119]
    ds_read_b64 v[176:177], v239 offset:160
    ds_read_b64 v[178:179], v239 offset:168
    ds_read_b128 v[180:183], v240 offset:192
    buffer_load_dwordx4 a[80:83], v3, s[48:51], s90 offen offset:0 sc1
    v_mfma_f32_32x32x16_bf16 v[120:135], v[136:139], v[144:147], v[120:135]
    ds_read_b128 v[184:187], v241 offset:192
    ds_read_b64 v[188:189], v239 offset:2208
    v_mfma_f32_32x32x16_bf16 v[120:135], v[148:151], v[152:155], v[120:135]
    ds_read_b64 v[190:191], v239 offset:2216
    ds_read_b128 v[192:195], v241 offset:2752
    buffer_load_dwordx4 a[84:87], v3, s[48:51], s90 offen offset:1024 sc1
    s_waitcnt lgkmcnt(7)
    v_mfma_f32_32x32x16_bf16 v[104:119], v[156:159], v[160:163], v[104:119]
    ds_read_b64 v[136:137], v239 offset:192
    ds_read_b64 v[138:139], v239 offset:200
    ds_read_b128 v[140:143], v240 offset:240
    buffer_load_dwordx4 a[88:91], v3, s[48:51], s90 offen offset:2048 sc1
    v_mfma_f32_32x32x16_bf16 v[120:135], v[156:159], v[164:167], v[120:135]
    ds_read_b128 v[144:147], v241 offset:240
    ds_read_b64 v[148:149], v239 offset:2240
    v_mfma_f32_32x32x16_bf16 v[120:135], v[168:171], v[172:175], v[120:135]
    ds_read_b64 v[150:151], v239 offset:2248
    ds_read_b128 v[152:155], v241 offset:2800
    buffer_load_dwordx4 a[92:95], v3, s[48:51], s90 offen offset:3072 sc1
    s_add_u32 s90, s90, 4096
    s_waitcnt lgkmcnt(7)
    v_mfma_f32_32x32x16_bf16 v[104:119], v[176:179], v[180:183], v[104:119]
    ds_read_b64 v[156:157], v239 offset:224
    ds_read_b64 v[158:159], v239 offset:232
    ds_read_b128 v[160:163], v240 offset:272
    buffer_load_dwordx4 a[96:99], v3, s[48:51], s90 offen offset:0 sc1
    v_mfma_f32_32x32x16_bf16 v[120:135], v[176:179], v[184:187], v[120:135]
    ds_read_b128 v[164:167], v241 offset:272
    ds_read_b64 v[168:169], v239 offset:2272
    v_mfma_f32_32x32x16_bf16 v[120:135], v[188:191], v[192:195], v[120:135]
    ds_read_b64 v[170:171], v239 offset:2280
    ds_read_b128 v[172:175], v241 offset:2832
    buffer_load_dwordx4 a[100:103], v3, s[48:51], s90 offen offset:1024 sc1
    s_waitcnt lgkmcnt(7)
    v_mfma_f32_32x32x16_bf16 v[104:119], v[136:139], v[140:143], v[104:119]
    ds_read_b64 v[176:177], v239 offset:256
    ds_read_b64 v[178:179], v239 offset:264
    ds_read_b128 v[180:183], v240 offset:320
    buffer_load_dwordx4 a[104:107], v3, s[48:51], s90 offen offset:2048 sc1
    v_mfma_f32_32x32x16_bf16 v[120:135], v[136:139], v[144:147], v[120:135]
    ds_read_b128 v[184:187], v241 offset:320
    ds_read_b64 v[188:189], v239 offset:2304
    v_mfma_f32_32x32x16_bf16 v[120:135], v[148:151], v[152:155], v[120:135]
    ds_read_b64 v[190:191], v239 offset:2312
    ds_read_b128 v[192:195], v241 offset:2880
    buffer_load_dwordx4 a[108:111], v3, s[48:51], s90 offen offset:3072 sc1
    s_add_u32 s90, s90, 4096
    s_waitcnt vmcnt(12)
    s_barrier
    s_lshl_b32 s75, s71, 7
    s_add_u32 s75, s75, 14681088
    v_mov_b32 v6, s75
    v_mov_b32 v7, 1
    s_cmp_eq_u32 s68, 0
    s_cselect_b64 exec, 1, 0
    global_atomic_add v6, v7, s[26:27] sc1
    s_mov_b64 exec, -1
    s_waitcnt lgkmcnt(7)
    v_mfma_f32_32x32x16_bf16 v[104:119], v[156:159], v[160:163], v[104:119]
    ds_read_b64 v[136:137], v239 offset:288
    ds_read_b64 v[138:139], v239 offset:296
    ds_read_b128 v[140:143], v240 offset:352
    buffer_load_dwordx4 a[112:115], v3, s[48:51], s90 offen offset:0 sc1
    v_mfma_f32_32x32x16_bf16 v[120:135], v[156:159], v[164:167], v[120:135]
    ds_read_b128 v[144:147], v241 offset:352
    ds_read_b64 v[148:149], v239 offset:2336
    v_mfma_f32_32x32x16_bf16 v[120:135], v[168:171], v[172:175], v[120:135]
    ds_read_b64 v[150:151], v239 offset:2344
    ds_read_b128 v[152:155], v241 offset:2912
    buffer_load_dwordx4 a[116:119], v3, s[48:51], s90 offen offset:1024 sc1
    s_waitcnt lgkmcnt(7)
    v_mfma_f32_32x32x16_bf16 v[104:119], v[176:179], v[180:183], v[104:119]
    ds_read_b64 v[156:157], v239 offset:320
    ds_read_b64 v[158:159], v239 offset:328
    ds_read_b128 v[160:163], v240 offset:400
    buffer_load_dwordx4 a[120:123], v3, s[48:51], s90 offen offset:2048 sc1
    v_mfma_f32_32x32x16_bf16 v[120:135], v[176:179], v[184:187], v[120:135]
    ds_read_b128 v[164:167], v241 offset:400
    ds_read_b64 v[168:169], v239 offset:2368
    v_mfma_f32_32x32x16_bf16 v[120:135], v[188:191], v[192:195], v[120:135]
    ds_read_b64 v[170:171], v239 offset:2376
    ds_read_b128 v[172:175], v241 offset:2960
    buffer_load_dwordx4 a[124:127], v3, s[48:51], s90 offen offset:3072 sc1
    s_add_u32 s90, s90, 4096
    s_waitcnt lgkmcnt(7)
    v_mfma_f32_32x32x16_bf16 v[104:119], v[136:139], v[140:143], v[104:119]
    ds_read_b64 v[176:177], v239 offset:352
    ds_read_b64 v[178:179], v239 offset:360
    ds_read_b128 v[180:183], v240 offset:432
    buffer_load_dwordx4 a[128:131], v3, s[48:51], s90 offen offset:0 sc1
    v_mfma_f32_32x32x16_bf16 v[120:135], v[136:139], v[144:147], v[120:135]
    ds_read_b128 v[184:187], v241 offset:432
    ds_read_b64 v[188:189], v239 offset:2400
    v_mfma_f32_32x32x16_bf16 v[120:135], v[148:151], v[152:155], v[120:135]
    ds_read_b64 v[190:191], v239 offset:2408
    ds_read_b128 v[192:195], v241 offset:2992
    buffer_load_dwordx4 a[132:135], v3, s[48:51], s90 offen offset:1024 sc1
    s_waitcnt lgkmcnt(7)
    v_mfma_f32_32x32x16_bf16 v[104:119], v[156:159], v[160:163], v[104:119]
    ds_read_b64 v[136:137], v239 offset:384
    ds_read_b64 v[138:139], v239 offset:392
    ds_read_b128 v[140:143], v240 offset:480
    v_mfma_f32_32x32x16_bf16 v[120:135], v[156:159], v[164:167], v[120:135]
    ds_read_b128 v[144:147], v241 offset:480
    ds_read_b64 v[148:149], v239 offset:2432
    v_mfma_f32_32x32x16_bf16 v[120:135], v[168:171], v[172:175], v[120:135]
    ds_read_b64 v[150:151], v239 offset:2440
    ds_read_b128 v[152:155], v241 offset:3040
    buffer_load_dwordx4 a[136:139], v3, s[48:51], s90 offen offset:2048 sc1
    s_waitcnt lgkmcnt(7)
    v_mfma_f32_32x32x16_bf16 v[104:119], v[176:179], v[180:183], v[104:119]
    ds_read_b64 v[156:157], v239 offset:416
    ds_read_b64 v[158:159], v239 offset:424
    ds_read_b128 v[160:163], v240 offset:512
    v_mfma_f32_32x32x16_bf16 v[120:135], v[176:179], v[184:187], v[120:135]
    ds_read_b128 v[164:167], v241 offset:512
    ds_read_b64 v[168:169], v239 offset:2464
    v_mfma_f32_32x32x16_bf16 v[120:135], v[188:191], v[192:195], v[120:135]
    ds_read_b64 v[170:171], v239 offset:2472
    ds_read_b128 v[172:175], v241 offset:3072
    buffer_load_dwordx4 a[140:143], v3, s[48:51], s90 offen offset:3072 sc1
    s_add_u32 s90, s90, 4096
    s_waitcnt lgkmcnt(7)
    v_mfma_f32_32x32x16_bf16 v[104:119], v[136:139], v[140:143], v[104:119]
    ds_read_b64 v[176:177], v239 offset:448
    ds_read_b64 v[178:179], v239 offset:456
    ds_read_b128 v[180:183], v240 offset:560
    v_mfma_f32_32x32x16_bf16 v[120:135], v[136:139], v[144:147], v[120:135]
    ds_read_b128 v[184:187], v241 offset:560
    ds_read_b64 v[188:189], v239 offset:2496
    v_mfma_f32_32x32x16_bf16 v[120:135], v[148:151], v[152:155], v[120:135]
    ds_read_b64 v[190:191], v239 offset:2504
    ds_read_b128 v[192:195], v241 offset:3120
    buffer_load_dwordx4 a[144:147], v3, s[48:51], s90 offen offset:0 sc1
    s_waitcnt lgkmcnt(7)
    v_mfma_f32_32x32x16_bf16 v[104:119], v[156:159], v[160:163], v[104:119]
    ds_read_b64 v[136:137], v239 offset:480
    ds_read_b64 v[138:139], v239 offset:488
    ds_read_b128 v[140:143], v240 offset:592
    v_mfma_f32_32x32x16_bf16 v[120:135], v[156:159], v[164:167], v[120:135]
    ds_read_b128 v[144:147], v241 offset:592
    ds_read_b64 v[148:149], v239 offset:2528
    v_mfma_f32_32x32x16_bf16 v[120:135], v[168:171], v[172:175], v[120:135]
    ds_read_b64 v[150:151], v239 offset:2536
    ds_read_b128 v[152:155], v241 offset:3152
    buffer_load_dwordx4 a[148:151], v3, s[48:51], s90 offen offset:1024 sc1
    s_waitcnt lgkmcnt(7)
    v_mfma_f32_32x32x16_bf16 v[104:119], v[176:179], v[180:183], v[104:119]
    ds_read_b64 v[156:157], v239 offset:512
    ds_read_b64 v[158:159], v239 offset:520
    ds_read_b128 v[160:163], v240 offset:640
    v_mfma_f32_32x32x16_bf16 v[120:135], v[176:179], v[184:187], v[120:135]
    ds_read_b128 v[164:167], v241 offset:640
    ds_read_b64 v[168:169], v239 offset:2560
    v_mfma_f32_32x32x16_bf16 v[120:135], v[188:191], v[192:195], v[120:135]
    ds_read_b64 v[170:171], v239 offset:2568
    ds_read_b128 v[172:175], v241 offset:3200
    buffer_load_dwordx4 a[152:155], v3, s[48:51], s90 offen offset:2048 sc1
    s_waitcnt lgkmcnt(7)
    v_mfma_f32_32x32x16_bf16 v[104:119], v[136:139], v[140:143], v[104:119]
    ds_read_b64 v[176:177], v239 offset:544
    ds_read_b64 v[178:179], v239 offset:552
    ds_read_b128 v[180:183], v240 offset:672
    v_mfma_f32_32x32x16_bf16 v[120:135], v[136:139], v[144:147], v[120:135]
    ds_read_b128 v[184:187], v241 offset:672
    ds_read_b64 v[188:189], v239 offset:2592
    v_mfma_f32_32x32x16_bf16 v[120:135], v[148:151], v[152:155], v[120:135]
    ds_read_b64 v[190:191], v239 offset:2600
    ds_read_b128 v[192:195], v241 offset:3232
    buffer_load_dwordx4 a[156:159], v3, s[48:51], s90 offen offset:3072 sc1
    s_add_u32 s90, s90, 4096
    s_waitcnt lgkmcnt(7)
    v_mfma_f32_32x32x16_bf16 v[104:119], v[156:159], v[160:163], v[104:119]
    ds_read_b64 v[136:137], v239 offset:576
    ds_read_b64 v[138:139], v239 offset:584
    ds_read_b128 v[140:143], v240 offset:720
    v_mfma_f32_32x32x16_bf16 v[120:135], v[156:159], v[164:167], v[120:135]
    ds_read_b128 v[144:147], v241 offset:720
    ds_read_b64 v[148:149], v239 offset:2624
    v_mfma_f32_32x32x16_bf16 v[120:135], v[168:171], v[172:175], v[120:135]
    ds_read_b64 v[150:151], v239 offset:2632
    ds_read_b128 v[152:155], v241 offset:3280
    buffer_load_dwordx4 a[160:163], v3, s[48:51], s90 offen offset:0 sc1
    s_waitcnt lgkmcnt(7)
    v_mfma_f32_32x32x16_bf16 v[104:119], v[176:179], v[180:183], v[104:119]
    ds_read_b64 v[156:157], v239 offset:608
    ds_read_b64 v[158:159], v239 offset:616
    ds_read_b128 v[160:163], v240 offset:752
    v_mfma_f32_32x32x16_bf16 v[120:135], v[176:179], v[184:187], v[120:135]
    ds_read_b128 v[164:167], v241 offset:752
    ds_read_b64 v[168:169], v239 offset:2656
    v_mfma_f32_32x32x16_bf16 v[120:135], v[188:191], v[192:195], v[120:135]
    ds_read_b64 v[170:171], v239 offset:2664
    ds_read_b128 v[172:175], v241 offset:3312
    buffer_load_dwordx4 a[164:167], v3, s[48:51], s90 offen offset:1024 sc1
    s_waitcnt lgkmcnt(7)
    v_mfma_f32_32x32x16_bf16 v[104:119], v[136:139], v[140:143], v[104:119]
    ds_read_b64 v[176:177], v239 offset:640
    ds_read_b64 v[178:179], v239 offset:648
    ds_read_b128 v[180:183], v240 offset:800
    v_mfma_f32_32x32x16_bf16 v[120:135], v[136:139], v[144:147], v[120:135]
    ds_read_b128 v[184:187], v241 offset:800
    ds_read_b64 v[188:189], v239 offset:2688
    v_mfma_f32_32x32x16_bf16 v[120:135], v[148:151], v[152:155], v[120:135]
    ds_read_b64 v[190:191], v239 offset:2696
    ds_read_b128 v[192:195], v241 offset:3360
    buffer_load_dwordx4 a[168:171], v3, s[48:51], s90 offen offset:2048 sc1
    s_waitcnt lgkmcnt(7)
    v_mfma_f32_32x32x16_bf16 v[104:119], v[156:159], v[160:163], v[104:119]
    ds_read_b64 v[136:137], v239 offset:672
    ds_read_b64 v[138:139], v239 offset:680
    ds_read_b128 v[140:143], v240 offset:832
    v_mfma_f32_32x32x16_bf16 v[120:135], v[156:159], v[164:167], v[120:135]
    ds_read_b128 v[144:147], v241 offset:832
    ds_read_b64 v[148:149], v239 offset:2720
    v_mfma_f32_32x32x16_bf16 v[120:135], v[168:171], v[172:175], v[120:135]
    ds_read_b64 v[150:151], v239 offset:2728
    ds_read_b128 v[152:155], v241 offset:3392
    buffer_load_dwordx4 a[172:175], v3, s[48:51], s90 offen offset:3072 sc1
    s_add_u32 s90, s90, 4096
    s_waitcnt lgkmcnt(7)
    v_mfma_f32_32x32x16_bf16 v[104:119], v[176:179], v[180:183], v[104:119]
    ds_read_b64 v[156:157], v239 offset:704
    ds_read_b64 v[158:159], v239 offset:712
    ds_read_b128 v[160:163], v240 offset:880
    v_mfma_f32_32x32x16_bf16 v[120:135], v[176:179], v[184:187], v[120:135]
    ds_read_b128 v[164:167], v241 offset:880
    ds_read_b64 v[168:169], v239 offset:2752
    v_mfma_f32_32x32x16_bf16 v[120:135], v[188:191], v[192:195], v[120:135]
    ds_read_b64 v[170:171], v239 offset:2760
    ds_read_b128 v[172:175], v241 offset:3440
    buffer_load_dwordx4 a[176:179], v3, s[48:51], s90 offen offset:0 sc1
    s_waitcnt lgkmcnt(7)
    v_mfma_f32_32x32x16_bf16 v[104:119], v[136:139], v[140:143], v[104:119]
    ds_read_b64 v[176:177], v239 offset:736
    ds_read_b64 v[178:179], v239 offset:744
    ds_read_b128 v[180:183], v240 offset:912
    v_mfma_f32_32x32x16_bf16 v[120:135], v[136:139], v[144:147], v[120:135]
    ds_read_b128 v[184:187], v241 offset:912
    ds_read_b64 v[188:189], v239 offset:2784
    v_mfma_f32_32x32x16_bf16 v[120:135], v[148:151], v[152:155], v[120:135]
    ds_read_b64 v[190:191], v239 offset:2792
    ds_read_b128 v[192:195], v241 offset:3472
    buffer_load_dwordx4 a[180:183], v3, s[48:51], s90 offen offset:1024 sc1
    s_waitcnt lgkmcnt(7)
    v_mfma_f32_32x32x16_bf16 v[104:119], v[156:159], v[160:163], v[104:119]
    ds_read_b64 v[136:137], v239 offset:768
    ds_read_b64 v[138:139], v239 offset:776
    ds_read_b128 v[140:143], v240 offset:960
    v_mfma_f32_32x32x16_bf16 v[120:135], v[156:159], v[164:167], v[120:135]
    ds_read_b128 v[144:147], v241 offset:960
    ds_read_b64 v[148:149], v239 offset:2816
    v_mfma_f32_32x32x16_bf16 v[120:135], v[168:171], v[172:175], v[120:135]
    ds_read_b64 v[150:151], v239 offset:2824
    ds_read_b128 v[152:155], v241 offset:3520
    buffer_load_dwordx4 a[184:187], v3, s[48:51], s90 offen offset:2048 sc1
    s_waitcnt lgkmcnt(7)
    v_mfma_f32_32x32x16_bf16 v[104:119], v[176:179], v[180:183], v[104:119]
    ds_read_b64 v[156:157], v239 offset:800
    ds_read_b64 v[158:159], v239 offset:808
    ds_read_b128 v[160:163], v240 offset:992
    v_mfma_f32_32x32x16_bf16 v[120:135], v[176:179], v[184:187], v[120:135]
    ds_read_b128 v[164:167], v241 offset:992
    ds_read_b64 v[168:169], v239 offset:2848
    v_mfma_f32_32x32x16_bf16 v[120:135], v[188:191], v[192:195], v[120:135]
    ds_read_b64 v[170:171], v239 offset:2856
    ds_read_b128 v[172:175], v241 offset:3552
    buffer_load_dwordx4 a[188:191], v3, s[48:51], s90 offen offset:3072 sc1
    s_add_u32 s90, s90, 4096
    s_waitcnt lgkmcnt(7)
    v_mfma_f32_32x32x16_bf16 v[104:119], v[136:139], v[140:143], v[104:119]
    ds_read_b64 v[176:177], v239 offset:832
    ds_read_b64 v[178:179], v239 offset:840
    ds_read_b128 v[180:183], v240 offset:1040
    v_mfma_f32_32x32x16_bf16 v[120:135], v[136:139], v[144:147], v[120:135]
    ds_read_b128 v[184:187], v241 offset:1040
    ds_read_b64 v[188:189], v239 offset:2880
    v_mfma_f32_32x32x16_bf16 v[120:135], v[148:151], v[152:155], v[120:135]
    ds_read_b64 v[190:191], v239 offset:2888
    ds_read_b128 v[192:195], v241 offset:3600
    buffer_load_dwordx4 a[192:195], v3, s[48:51], s90 offen offset:0 sc1
    s_lshr_b32 s82, s88, 1
    s_lshl_b32 s75, s82, 7
    s_add_u32 s75, s75, 14681088
    v_mov_b32 v6, s75
    s_cmp_eq_u32 s68, 0
    s_cselect_b64 exec, 1, 0
    global_load_dword v7, v6, s[26:27] sc1
    s_mov_b64 exec, -1
    s_waitcnt lgkmcnt(7)
    v_mfma_f32_32x32x16_bf16 v[104:119], v[156:159], v[160:163], v[104:119]
    ds_read_b64 v[136:137], v239 offset:864
    ds_read_b64 v[138:139], v239 offset:872
    ds_read_b128 v[140:143], v240 offset:1072
    v_mfma_f32_32x32x16_bf16 v[120:135], v[156:159], v[164:167], v[120:135]
    ds_read_b128 v[144:147], v241 offset:1072
    ds_read_b64 v[148:149], v239 offset:2912
    v_mfma_f32_32x32x16_bf16 v[120:135], v[168:171], v[172:175], v[120:135]
    ds_read_b64 v[150:151], v239 offset:2920
    ds_read_b128 v[152:155], v241 offset:3632
    buffer_load_dwordx4 a[196:199], v3, s[48:51], s90 offen offset:1024 sc1
    s_waitcnt lgkmcnt(7)
    v_mfma_f32_32x32x16_bf16 v[104:119], v[176:179], v[180:183], v[104:119]
    ds_read_b64 v[156:157], v239 offset:896
    ds_read_b64 v[158:159], v239 offset:904
    ds_read_b128 v[160:163], v240 offset:1120
    v_mfma_f32_32x32x16_bf16 v[120:135], v[176:179], v[184:187], v[120:135]
    ds_read_b128 v[164:167], v241 offset:1120
    ds_read_b64 v[168:169], v239 offset:2944
    v_mfma_f32_32x32x16_bf16 v[120:135], v[188:191], v[192:195], v[120:135]
    ds_read_b64 v[170:171], v239 offset:2952
    ds_read_b128 v[172:175], v241 offset:3680
    buffer_load_dwordx4 a[200:203], v3, s[48:51], s90 offen offset:2048 sc1
    s_waitcnt lgkmcnt(7)
    v_mfma_f32_32x32x16_bf16 v[104:119], v[136:139], v[140:143], v[104:119]
    ds_read_b64 v[176:177], v239 offset:928
    ds_read_b64 v[178:179], v239 offset:936
    ds_read_b128 v[180:183], v240 offset:1152
    v_mfma_f32_32x32x16_bf16 v[120:135], v[136:139], v[144:147], v[120:135]
    ds_read_b128 v[184:187], v241 offset:1152
    ds_read_b64 v[188:189], v239 offset:2976
    v_mfma_f32_32x32x16_bf16 v[120:135], v[148:151], v[152:155], v[120:135]
    ds_read_b64 v[190:191], v239 offset:2984
    ds_read_b128 v[192:195], v241 offset:3712
    buffer_load_dwordx4 a[204:207], v3, s[48:51], s90 offen offset:3072 sc1
    s_add_u32 s90, s90, 4096
    s_waitcnt lgkmcnt(7)
    v_mfma_f32_32x32x16_bf16 v[104:119], v[156:159], v[160:163], v[104:119]
    ds_read_b64 v[136:137], v239 offset:960
    ds_read_b64 v[138:139], v239 offset:968
    ds_read_b128 v[140:143], v240 offset:1200
    v_mfma_f32_32x32x16_bf16 v[120:135], v[156:159], v[164:167], v[120:135]
    ds_read_b128 v[144:147], v241 offset:1200
    ds_read_b64 v[148:149], v239 offset:3008
    v_mfma_f32_32x32x16_bf16 v[120:135], v[168:171], v[172:175], v[120:135]
    ds_read_b64 v[150:151], v239 offset:3016
    ds_read_b128 v[152:155], v241 offset:3760
    buffer_load_dwordx4 a[208:211], v3, s[48:51], s90 offen offset:0 sc1
    s_waitcnt lgkmcnt(7)
    v_mfma_f32_32x32x16_bf16 v[104:119], v[176:179], v[180:183], v[104:119]
    ds_read_b64 v[156:157], v239 offset:992
    ds_read_b64 v[158:159], v239 offset:1000
    ds_read_b128 v[160:163], v240 offset:1232
    v_mfma_f32_32x32x16_bf16 v[120:135], v[176:179], v[184:187], v[120:135]
    ds_read_b128 v[164:167], v241 offset:1232
    ds_read_b64 v[168:169], v239 offset:3040
    v_mfma_f32_32x32x16_bf16 v[120:135], v[188:191], v[192:195], v[120:135]
    ds_read_b64 v[170:171], v239 offset:3048
    ds_read_b128 v[172:175], v241 offset:3792
    buffer_load_dwordx4 a[212:215], v3, s[48:51], s90 offen offset:1024 sc1
    s_waitcnt lgkmcnt(7)
    v_mfma_f32_32x32x16_bf16 v[104:119], v[136:139], v[140:143], v[104:119]
    v_mfma_f32_32x32x16_bf16 v[120:135], v[136:139], v[144:147], v[120:135]
    v_mfma_f32_32x32x16_bf16 v[120:135], v[148:151], v[152:155], v[120:135]
    buffer_load_dwordx4 a[216:219], v3, s[48:51], s90 offen offset:2048 sc1
    s_waitcnt lgkmcnt(0)
    v_mfma_f32_32x32x16_bf16 v[104:119], v[156:159], v[160:163], v[104:119]
    v_mfma_f32_32x32x16_bf16 v[120:135], v[156:159], v[164:167], v[120:135]
    v_mfma_f32_32x32x16_bf16 v[120:135], v[168:171], v[172:175], v[120:135]
    buffer_load_dwordx4 a[220:223], v3, s[48:51], s90 offen offset:3072 sc1
    s_add_u32 s90, s90, 4096
    s_waitcnt vmcnt(7)
    s_mov_b32 s67, 0
    s_cmp_lg_u32 s68, 0
    s_cbranch_scc1 L_pk_H
L_pl_H:
    v_cmp_le_u32 vcc, 16, v7
    s_nop 1
    s_and_b32 s75, vcc_lo, 1
    s_cmp_eq_u32 s75, 1
    s_cbranch_scc1 L_pk_H
    s_sleep 4
    s_mov_b64 exec, 1
    global_load_dword v7, v6, s[26:27] sc1
    s_mov_b64 exec, -1
    s_waitcnt vmcnt(0)
    s_add_u32 s67, s67, 1
    s_cmp_lt_u32 s67, 0x40000
    s_cbranch_scc1 L_pl_H
L_pk_H:
    s_nop 7
    s_nop 3
    s_cmp_eq_u32 s19, 0
    s_cbranch_scc1 L_noswap
    v_swap_b32 v104, v120
    v_swap_b32 v105, v121
    v_swap_b32 v106, v122
    v_swap_b32 v107, v123
    v_swap_b32 v108, v124
    v_swap_b32 v109, v125
    v_swap_b32 v110, v126
    v_swap_b32 v111, v127
    v_swap_b32 v112, v128
    v_swap_b32 v113, v129
    v_swap_b32 v114, v130
    v_swap_b32 v115, v131
    v_swap_b32 v116, v132
    v_swap_b32 v117, v133
    v_swap_b32 v118, v134
    v_swap_b32 v119, v135
L_noswap:
    s_lshl_b32 s74, s68, 12
    s_add_u32 s74, s74, 16384
    v_add_u32 v251, s74, v3
    ds_write_b128 v251, v[120:123] offset:0
    ds_write_b128 v251, v[124:127] offset:1024
    ds_write_b128 v251, v[128:131] offset:2048
    ds_write_b128 v251, v[132:135] offset:3072
    s_xor_b32 s74, s74, 4096
    v_add_u32 v251, s74, v3
    ds_read_b64 v[136:137], v238 offset:48
    ds_read_b64 v[138:139], v238 offset:32
    ds_read_b64 v[140:141], v238 offset:16
    ds_read_b64 v[142:143], v238 offset:0
    s_waitcnt lgkmcnt(0)
    s_barrier
    ds_read_b128 v[144:147], v251 offset:0
    ds_read_b128 v[148:151], v251 offset:1024
    ds_read_b128 v[152:155], v251 offset:2048
    ds_read_b128 v[156:159], v251 offset:3072
    buffer_load_dwordx4 v[8:11], v246, s[48:51], s4 offen sc1
    buffer_load_dwordx4 v[12:15], v247, s[48:51], s4 offen sc1
    buffer_load_dwordx4 v[16:19], v248, s[48:51], s4 offen sc1
    buffer_load_dwordx4 v[20:23], v249, s[48:51], s4 offen sc1
    buffer_load_dwordx4 v[24:27], v246, s[48:51], s5 offen sc1
    buffer_load_dwordx4 v[28:31], v247, s[48:51], s5 offen sc1
    buffer_load_dwordx4 v[32:35], v248, s[48:51], s5 offen sc1
    buffer_load_dwordx4 v[36:39], v249, s[48:51], s5 offen sc1
    v_and_b32 v252, 31, v1
    v_mul_u32_u24 v252, 80, v252
    v_lshrrev_b32 v253, 5, v1
    v_lshl_add_u32 v252, v253, 3, v252
    s_mul_i32 s74, s18, 5120
    s_mul_i32 s75, s19, 2560
    s_add_u32 s74, s74, s75
    s_add_u32 s74, s74, 32768
    v_add_u32 v252, s74, v252
    buffer_load_dwordx4 v[40:43], v246, s[48:51], s6 offen sc1
    s_lshl_b32 s74, s95, 16
    s_and_b32 s75, s95, 0xffff0000
    s_cmp_eq_u32 s18, 0
    s_cselect_b32 s74, s74, s75
    v_mov_b32 v6, s74
    v_mov_b32 v7, s74
    s_waitcnt lgkmcnt(3)
    v_pk_add_f32 v[104:105], v[104:105], v[144:145]
    v_pk_add_f32 v[106:107], v[106:107], v[146:147]
    v_and_b32 v160, 0xffff0000, v137
    v_lshlrev_b32 v161, 16, v137
    v_and_b32 v162, 0xffff0000, v136
    buffer_load_dwordx4 v[44:47], v247, s[48:51], s6 offen sc1
    v_lshlrev_b32 v163, 16, v136
    v_pk_fma_f32 v[104:105], v[160:161], v[6:7], v[104:105]
    v_pk_fma_f32 v[106:107], v[162:163], v[6:7], v[106:107]
    v_cvt_pk_bf16_f32 v164, v104, v105
    v_cvt_pk_bf16_f32 v165, v106, v107
    buffer_load_dwordx4 v[48:51], v248, s[48:51], s6 offen sc1
    ds_write_b64 v252, v[164:165] offset:0
    s_waitcnt lgkmcnt(3)
    v_pk_add_f32 v[108:109], v[108:109], v[148:149]
    v_pk_add_f32 v[110:111], v[110:111], v[150:151]
    v_and_b32 v160, 0xffff0000, v139
    v_lshlrev_b32 v161, 16, v139
    v_and_b32 v162, 0xffff0000, v138
    buffer_load_dwordx4 v[52:55], v249, s[48:51], s6 offen sc1
    v_lshlrev_b32 v163, 16, v138
    v_pk_fma_f32 v[108:109], v[160:161], v[6:7], v[108:109]
    v_pk_fma_f32 v[110:111], v[162:163], v[6:7], v[110:111]
    v_cvt_pk_bf16_f32 v166, v108, v109
    v_cvt_pk_bf16_f32 v167, v110, v111
    buffer_load_dwordx4 v[56:59], v246, s[48:51], s7 offen sc1
    ds_write_b64 v252, v[166:167] offset:16
    s_waitcnt lgkmcnt(3)
    v_pk_add_f32 v[112:113], v[112:113], v[152:153]
    v_pk_add_f32 v[114:115], v[114:115], v[154:155]
    v_and_b32 v160, 0xffff0000, v141
    v_lshlrev_b32 v161, 16, v141
    v_and_b32 v162, 0xffff0000, v140
    buffer_load_dwordx4 v[60:63], v247, s[48:51], s7 offen sc1
    v_lshlrev_b32 v163, 16, v140
    v_pk_fma_f32 v[112:113], v[160:161], v[6:7], v[112:113]
    v_pk_fma_f32 v[114:115], v[162:163], v[6:7], v[114:115]
    v_cvt_pk_bf16_f32 v168, v112, v113
    v_cvt_pk_bf16_f32 v169, v114, v115
    buffer_load_dwordx4 v[64:67], v248, s[48:51], s7 offen sc1
    ds_write_b64 v252, v[168:169] offset:32
    s_waitcnt lgkmcnt(3)
    v_pk_add_f32 v[116:117], v[116:117], v[156:157]
    v_pk_add_f32 v[118:119], v[118:119], v[158:159]
    v_and_b32 v160, 0xffff0000, v143
    v_lshlrev_b32 v161, 16, v143
    v_and_b32 v162, 0xffff0000, v142
    buffer_load_dwordx4 v[68:71], v249, s[48:51], s7 offen sc1
    v_lshlrev_b32 v163, 16, v142
    v_pk_fma_f32 v[116:117], v[160:161], v[6:7], v[116:117]
    v_pk_fma_f32 v[118:119], v[162:163], v[6:7], v[118:119]
    v_cvt_pk_bf16_f32 v170, v116, v117
    v_cvt_pk_bf16_f32 v171, v118, v119
    buffer_load_dwordx4 v[72:75], v246, s[48:51], s8 offen sc1
    ds_write_b64 v252, v[170:171] offset:48
    v_lshrrev_b32 v250, 2, v0
    v_mul_u32_u24 v250, 80, v250
    v_and_b32 v251, 3, v0
    v_lshl_add_u32 v250, v251, 4, v250
    v_add_u32 v250, 32768, v250
    s_lshl_b32 s74, s69, 18
    s_lshl_b32 s75, s70, 13
    s_add_u32 s74, s74, s75
    s_add_u32 s82, s74, 12582912
    s_add_u32 s83, s82, 4096
    v_lshlrev_b32 v251, 4, v0
    s_waitcnt lgkmcnt(0)
    s_barrier
    ds_read_b128 v[104:107], v250
    ds_read_b128 v[108:111], v250 offset:5120
    s_waitcnt lgkmcnt(0)
    buffer_store_dwordx4 v[104:107], v251, s[48:51], s82 offen sc1
    buffer_store_dwordx4 v[108:111], v251, s[48:51], s83 offen sc1
    s_waitcnt vmcnt(15)
    v_mfma_f32_16x16x32_bf16 v[112:115], a[0:3], v[8:11], 0
    buffer_load_dwordx4 v[76:79], v247, s[48:51], s8 offen sc1
    v_mfma_f32_16x16x32_bf16 v[116:119], a[0:3], v[12:15], 0
    v_mfma_f32_16x16x32_bf16 v[120:123], a[0:3], v[16:19], 0
    v_mfma_f32_16x16x32_bf16 v[124:127], a[0:3], v[20:23], 0
    buffer_load_dwordx4 v[80:83], v248, s[48:51], s8 offen sc1
    v_mfma_f32_16x16x32_bf16 v[128:131], a[4:7], v[8:11], 0
    v_mfma_f32_16x16x32_bf16 v[132:135], a[4:7], v[12:15], 0
    v_mfma_f32_16x16x32_bf16 v[136:139], a[4:7], v[16:19], 0
    buffer_load_dwordx4 v[84:87], v249, s[48:51], s8 offen sc1
    v_mfma_f32_16x16x32_bf16 v[140:143], a[4:7], v[20:23], 0
    v_mfma_f32_16x16x32_bf16 v[144:147], a[8:11], v[8:11], 0
    v_mfma_f32_16x16x32_bf16 v[148:151], a[8:11], v[12:15], 0
    buffer_load_dwordx4 v[88:91], v246, s[48:51], s9 offen sc1
    v_mfma_f32_16x16x32_bf16 v[152:155], a[8:11], v[16:19], 0
    v_mfma_f32_16x16x32_bf16 v[156:159], a[8:11], v[20:23], 0
    v_mfma_f32_16x16x32_bf16 v[160:163], a[12:15], v[8:11], 0
    buffer_load_dwordx4 v[92:95], v247, s[48:51], s9 offen sc1
    v_mfma_f32_16x16x32_bf16 v[164:167], a[12:15], v[12:15], 0
    v_mfma_f32_16x16x32_bf16 v[168:171], a[12:15], v[16:19], 0
    v_mfma_f32_16x16x32_bf16 v[172:175], a[12:15], v[20:23], 0
    buffer_load_dwordx4 v[96:99], v248, s[48:51], s9 offen sc1
    s_waitcnt vmcnt(17)
    v_mfma_f32_16x16x32_bf16 v[112:115], a[16:19], v[24:27], v[112:115]
    buffer_load_dwordx4 v[100:103], v249, s[48:51], s9 offen sc1
    v_mfma_f32_16x16x32_bf16 v[116:119], a[16:19], v[28:31], v[116:119]
    v_mfma_f32_16x16x32_bf16 v[120:123], a[16:19], v[32:35], v[120:123]
    v_mfma_f32_16x16x32_bf16 v[124:127], a[16:19], v[36:39], v[124:127]
    buffer_load_dwordx4 v[8:11], v246, s[48:51], s10 offen sc1
    v_mfma_f32_16x16x32_bf16 v[128:131], a[20:23], v[24:27], v[128:131]
    v_mfma_f32_16x16x32_bf16 v[132:135], a[20:23], v[28:31], v[132:135]
    v_mfma_f32_16x16x32_bf16 v[136:139], a[20:23], v[32:35], v[136:139]
    buffer_load_dwordx4 v[12:15], v247, s[48:51], s10 offen sc1
    v_mfma_f32_16x16x32_bf16 v[140:143], a[20:23], v[36:39], v[140:143]
    v_mfma_f32_16x16x32_bf16 v[144:147], a[24:27], v[24:27], v[144:147]
    v_mfma_f32_16x16x32_bf16 v[148:151], a[24:27], v[28:31], v[148:151]
    buffer_load_dwordx4 v[16:19], v248, s[48:51], s10 offen sc1
    v_mfma_f32_16x16x32_bf16 v[152:155], a[24:27], v[32:35], v[152:155]
    v_mfma_f32_16x16x32_bf16 v[156:159], a[24:27], v[36:39], v[156:159]
    v_mfma_f32_16x16x32_bf16 v[160:163], a[28:31], v[24:27], v[160:163]
    buffer_load_dwordx4 v[20:23], v249, s[48:51], s10 offen sc1
    v_mfma_f32_16x16x32_bf16 v[164:167], a[28:31], v[28:31], v[164:167]
    v_mfma_f32_16x16x32_bf16 v[168:171], a[28:31], v[32:35], v[168:171]
    v_mfma_f32_16x16x32_bf16 v[172:175], a[28:31], v[36:39], v[172:175]
    buffer_load_dwordx4 v[24:27], v246, s[48:51], s11 offen sc1
    s_waitcnt vmcnt(12)
    s_barrier
    v_mfma_f32_16x16x32_bf16 v[112:115], a[32:35], v[40:43], v[112:115]
    buffer_load_dwordx4 v[28:31], v247, s[48:51], s11 offen sc1
    v_mfma_f32_16x16x32_bf16 v[116:119], a[32:35], v[44:47], v[116:119]
    v_mfma_f32_16x16x32_bf16 v[120:123], a[32:35], v[48:51], v[120:123]
    s_lshl_b32 s75, s69, 7
    s_add_u32 s75, s75, 14683136
    v_mov_b32 v236, s75
    v_mov_b32 v237, 1
    s_cmp_eq_u32 s68, 0
    s_cselect_b64 exec, 1, 0
    global_atomic_add v236, v237, s[26:27] sc1
    s_mov_b64 exec, -1
    v_mfma_f32_16x16x32_bf16 v[124:127], a[32:35], v[52:55], v[124:127]
    buffer_load_dwordx4 v[32:35], v248, s[48:51], s11 offen sc1
    v_mfma_f32_16x16x32_bf16 v[128:131], a[36:39], v[40:43], v[128:131]
    v_mfma_f32_16x16x32_bf16 v[132:135], a[36:39], v[44:47], v[132:135]
    v_mfma_f32_16x16x32_bf16 v[136:139], a[36:39], v[48:51], v[136:139]
    buffer_load_dwordx4 v[36:39], v249, s[48:51], s11 offen sc1
    v_mfma_f32_16x16x32_bf16 v[140:143], a[36:39], v[52:55], v[140:143]
    v_mfma_f32_16x16x32_bf16 v[144:147], a[40:43], v[40:43], v[144:147]
    v_mfma_f32_16x16x32_bf16 v[148:151], a[40:43], v[44:47], v[148:151]
    v_mfma_f32_16x16x32_bf16 v[152:155], a[40:43], v[48:51], v[152:155]
    v_mfma_f32_16x16x32_bf16 v[156:159], a[40:43], v[52:55], v[156:159]
    v_mfma_f32_16x16x32_bf16 v[160:163], a[44:47], v[40:43], v[160:163]
    buffer_load_dwordx4 v[40:43], v246, s[48:51], s12 offen sc1
    v_mfma_f32_16x16x32_bf16 v[164:167], a[44:47], v[44:47], v[164:167]
    v_mfma_f32_16x16x32_bf16 v[168:171], a[44:47], v[48:51], v[168:171]
    v_mfma_f32_16x16x32_bf16 v[172:175], a[44:47], v[52:55], v[172:175]
    buffer_load_dwordx4 v[44:47], v247, s[48:51], s12 offen sc1
    v_mfma_f32_16x16x32_bf16 v[112:115], a[48:51], v[56:59], v[112:115]
    buffer_load_dwordx4 v[48:51], v248, s[48:51], s12 offen sc1
    v_mfma_f32_16x16x32_bf16 v[116:119], a[48:51], v[60:63], v[116:119]
    v_mfma_f32_16x16x32_bf16 v[120:123], a[48:51], v[64:67], v[120:123]
    v_mfma_f32_16x16x32_bf16 v[124:127], a[48:51], v[68:71], v[124:127]
    buffer_load_dwordx4 v[52:55], v249, s[48:51], s12 offen sc1
    v_mfma_f32_16x16x32_bf16 v[128:131], a[52:55], v[56:59], v[128:131]
    v_mfma_f32_16x16x32_bf16 v[132:135], a[52:55], v[60:63], v[132:135]
    v_mfma_f32_16x16x32_bf16 v[136:139], a[52:55], v[64:67], v[136:139]
    v_mfma_f32_16x16x32_bf16 v[140:143], a[52:55], v[68:71], v[140:143]
    v_mfma_f32_16x16x32_bf16 v[144:147], a[56:59], v[56:59], v[144:147]
    v_mfma_f32_16x16x32_bf16 v[148:151], a[56:59], v[60:63], v[148:151]
    v_mfma_f32_16x16x32_bf16 v[152:155], a[56:59], v[64:67], v[152:155]
    v_mfma_f32_16x16x32_bf16 v[156:159], a[56:59], v[68:71], v[156:159]
    v_mfma_f32_16x16x32_bf16 v[160:163], a[60:63], v[56:59], v[160:163]
    buffer_load_dwordx4 v[56:59], v246, s[48:51], s13 offen sc1
    v_mfma_f32_16x16x32_bf16 v[164:167], a[60:63], v[60:63], v[164:167]
    v_mfma_f32_16x16x32_bf16 v[168:171], a[60:63], v[64:67], v[168:171]
    v_mfma_f32_16x16x32_bf16 v[172:175], a[60:63], v[68:71], v[172:175]
    buffer_load_dwordx4 v[60:63], v247, s[48:51], s13 offen sc1
    s_waitcnt vmcnt(19)
    v_mfma_f32_16x16x32_bf16 v[112:115], a[64:67], v[72:75], v[112:115]
    buffer_load_dwordx4 v[64:67], v248, s[48:51], s13 offen sc1
    v_mfma_f32_16x16x32_bf16 v[116:119], a[64:67], v[76:79], v[116:119]
    v_mfma_f32_16x16x32_bf16 v[120:123], a[64:67], v[80:83], v[120:123]
    v_mfma_f32_16x16x32_bf16 v[124:127], a[64:67], v[84:87], v[124:127]
    buffer_load_dwordx4 v[68:71], v249, s[48:51], s13 offen sc1
    v_mfma_f32_16x16x32_bf16 v[128:131], a[68:71], v[72:75], v[128:131]
    v_mfma_f32_16x16x32_bf16 v[132:135], a[68:71], v[76:79], v[132:135]
    v_mfma_f32_16x16x32_bf16 v[136:139], a[68:71], v[80:83], v[136:139]
    v_mfma_f32_16x16x32_bf16 v[140:143], a[68:71], v[84:87], v[140:143]
    v_mfma_f32_16x16x32_bf16 v[144:147], a[72:75], v[72:75], v[144:147]
    v_mfma_f32_16x16x32_bf16 v[148:151], a[72:75], v[76:79], v[148:151]
    v_mfma_f32_16x16x32_bf16 v[152:155], a[72:75], v[80:83], v[152:155]
    v_mfma_f32_16x16x32_bf16 v[156:159], a[72:75], v[84:87], v[156:159]
    v_mfma_f32_16x16x32_bf16 v[160:163], a[76:79], v[72:75], v[160:163]
    buffer_load_dwordx4 v[72:75], v246, s[48:51], s14 offen sc1
    v_mfma_f32_16x16x32_bf16 v[164:167], a[76:79], v[76:79], v[164:167]
    v_mfma_f32_16x16x32_bf16 v[168:171], a[76:79], v[80:83], v[168:171]
    v_mfma_f32_16x16x32_bf16 v[172:175], a[76:79], v[84:87], v[172:175]
    buffer_load_dwordx4 v[76:79], v247, s[48:51], s14 offen sc1
    s_waitcnt vmcnt(19)
    v_mfma_f32_16x16x32_bf16 v[112:115], a[80:83], v[88:91], v[112:115]
    buffer_load_dwordx4 v[80:83], v248, s[48:51], s14 offen sc1
    v_mfma_f32_16x16x32_bf16 v[116:119], a[80:83], v[92:95], v[116:119]
    v_mfma_f32_16x16x32_bf16 v[120:123], a[80:83], v[96:99], v[120:123]
    v_and_b32 v188, 15, v1
    v_lshrrev_b32 v189, 4, v1
    s_lshl_b32 s74, s88, 6
    s_lshl_b32 s75, s68, 4
    s_add_u32 s74, s74, s75
    v_add_u32 v188, s74, v188
    v_lshlrev_b32 v184, 10, v188
    v_lshl_add_u32 v184, v189, 5, v184
    s_lshl_b32 s74, s89, 7
    v_add_u32 v184, s74, v184
    buffer_load_dwordx4 v[176:179], v184, s[28:31], 0 offen
    buffer_load_dwordx4 v[180:183], v184, s[28:31], 0 offen offset:16
    v_lshlrev_b32 v188, 3, v188
    s_mov_b32 s74, 11534336
    buffer_load_dwordx2 v[6:7], v188, s[48:51], s74 offen sc1
    v_mfma_f32_16x16x32_bf16 v[124:127], a[80:83], v[100:103], v[124:127]
    buffer_load_dwordx4 v[84:87], v249, s[48:51], s14 offen sc1
    v_mfma_f32_16x16x32_bf16 v[128:131], a[84:87], v[88:91], v[128:131]
    v_mfma_f32_16x16x32_bf16 v[132:135], a[84:87], v[92:95], v[132:135]
    v_mfma_f32_16x16x32_bf16 v[136:139], a[84:87], v[96:99], v[136:139]
    v_mfma_f32_16x16x32_bf16 v[140:143], a[84:87], v[100:103], v[140:143]
    v_mfma_f32_16x16x32_bf16 v[144:147], a[88:91], v[88:91], v[144:147]
    v_mfma_f32_16x16x32_bf16 v[148:151], a[88:91], v[92:95], v[148:151]
    v_mfma_f32_16x16x32_bf16 v[152:155], a[88:91], v[96:99], v[152:155]
    v_mfma_f32_16x16x32_bf16 v[156:159], a[88:91], v[100:103], v[156:159]
    v_mfma_f32_16x16x32_bf16 v[160:163], a[92:95], v[88:91], v[160:163]
    buffer_load_dwordx4 v[88:91], v246, s[48:51], s15 offen sc1
    v_mfma_f32_16x16x32_bf16 v[164:167], a[92:95], v[92:95], v[164:167]
    v_mfma_f32_16x16x32_bf16 v[168:171], a[92:95], v[96:99], v[168:171]
    v_mfma_f32_16x16x32_bf16 v[172:175], a[92:95], v[100:103], v[172:175]
    buffer_load_dwordx4 v[92:95], v247, s[48:51], s15 offen sc1
    s_waitcnt vmcnt(22)
    v_mfma_f32_16x16x32_bf16 v[112:115], a[96:99], v[8:11], v[112:115]
    buffer_load_dwordx4 v[96:99], v248, s[48:51], s15 offen sc1
    v_mfma_f32_16x16x32_bf16 v[116:119], a[96:99], v[12:15], v[116:119]
    v_mfma_f32_16x16x32_bf16 v[120:123], a[96:99], v[16:19], v[120:123]
    s_mul_i32 s74, s68, 12288
    s_add_u32 s74, s74, 0
    v_add_u32 v104, s74, v3
    s_add_u32 s74, s68, 1
    s_and_b32 s74, s74, 3
    s_mul_i32 s74, s74, 12288
    s_add_u32 s74, s74, 0
    v_add_u32 v106, s74, v3
    s_add_u32 s74, s68, 2
    s_and_b32 s74, s74, 3
    s_mul_i32 s74, s74, 12288
    s_add_u32 s74, s74, 4096
    v_add_u32 v107, s74, v3
    s_add_u32 s74, s68, 3
    s_and_b32 s74, s74, 3
    s_mul_i32 s74, s74, 12288
    s_add_u32 s74, s74, 8192
    v_add_u32 v108, s74, v3
    v_mfma_f32_16x16x32_bf16 v[124:127], a[96:99], v[20:23], v[124:127]
    buffer_load_dwordx4 v[100:103], v249, s[48:51], s15 offen sc1
    v_mfma_f32_16x16x32_bf16 v[128:131], a[100:103], v[8:11], v[128:131]
    v_mfma_f32_16x16x32_bf16 v[132:135], a[100:103], v[12:15], v[132:135]
    v_mfma_f32_16x16x32_bf16 v[136:139], a[100:103], v[16:19], v[136:139]
    v_mfma_f32_16x16x32_bf16 v[140:143], a[100:103], v[20:23], v[140:143]
    v_mfma_f32_16x16x32_bf16 v[144:147], a[104:107], v[8:11], v[144:147]
    v_mfma_f32_16x16x32_bf16 v[148:151], a[104:107], v[12:15], v[148:151]
    v_mfma_f32_16x16x32_bf16 v[152:155], a[104:107], v[16:19], v[152:155]
    v_mfma_f32_16x16x32_bf16 v[156:159], a[104:107], v[20:23], v[156:159]
    v_mfma_f32_16x16x32_bf16 v[160:163], a[108:111], v[8:11], v[160:163]
    buffer_load_dwordx4 v[8:11], v246, s[48:51], s16 offen sc1
    v_mfma_f32_16x16x32_bf16 v[164:167], a[108:111], v[12:15], v[164:167]
    v_mfma_f32_16x16x32_bf16 v[168:171], a[108:111], v[16:19], v[168:171]
    v_mfma_f32_16x16x32_bf16 v[172:175], a[108:111], v[20:23], v[172:175]
    buffer_load_dwordx4 v[12:15], v247, s[48:51], s16 offen sc1
    s_waitcnt vmcnt(21)
    v_mfma_f32_16x16x32_bf16 v[112:115], a[112:115], v[24:27], v[112:115]
    buffer_load_dwordx4 v[16:19], v248, s[48:51], s16 offen sc1
    v_mfma_f32_16x16x32_bf16 v[116:119], a[112:115], v[28:31], v[116:119]
    v_mfma_f32_16x16x32_bf16 v[120:123], a[112:115], v[32:35], v[120:123]
    v_lshrrev_b32 v105, 4, v1
    v_lshlrev_b32 v105, 4, v105
    v_bfe_u32 v109, v1, 2, 2
    v_add_u32 v105, v105, v109
    v_mul_u32_u24 v105, 144, v105
    v_and_b32 v109, 3, v1
    v_lshl_add_u32 v105, v109, 3, v105
    s_lshl_b32 s74, s68, 5
    s_add_u32 s74, s74, 65536
    v_add_u32 v105, s74, v105
    v_mfma_f32_16x16x32_bf16 v[124:127], a[112:115], v[36:39], v[124:127]
    buffer_load_dwordx4 v[20:23], v249, s[48:51], s16 offen sc1
    v_mfma_f32_16x16x32_bf16 v[128:131], a[116:119], v[24:27], v[128:131]
    v_mfma_f32_16x16x32_bf16 v[132:135], a[116:119], v[28:31], v[132:135]
    v_mfma_f32_16x16x32_bf16 v[136:139], a[116:119], v[32:35], v[136:139]
    v_mfma_f32_16x16x32_bf16 v[140:143], a[116:119], v[36:39], v[140:143]
    v_mfma_f32_16x16x32_bf16 v[144:147], a[120:123], v[24:27], v[144:147]
    v_mfma_f32_16x16x32_bf16 v[148:151], a[120:123], v[28:31], v[148:151]
    v_mfma_f32_16x16x32_bf16 v[152:155], a[120:123], v[32:35], v[152:155]
    v_mfma_f32_16x16x32_bf16 v[156:159], a[120:123], v[36:39], v[156:159]
    v_mfma_f32_16x16x32_bf16 v[160:163], a[124:127], v[24:27], v[160:163]
    buffer_load_dwordx4 v[24:27], v246, s[48:51], s17 offen sc1
    v_mfma_f32_16x16x32_bf16 v[164:167], a[124:127], v[28:31], v[164:167]
    v_mfma_f32_16x16x32_bf16 v[168:171], a[124:127], v[32:35], v[168:171]
    v_mfma_f32_16x16x32_bf16 v[172:175], a[124:127], v[36:39], v[172:175]
    buffer_load_dwordx4 v[28:31], v247, s[48:51], s17 offen sc1
    s_waitcnt vmcnt(21)
    v_mfma_f32_16x16x32_bf16 v[112:115], a[128:131], v[40:43], v[112:115]
    buffer_load_dwordx4 v[32:35], v248, s[48:51], s17 offen sc1
    v_mfma_f32_16x16x32_bf16 v[116:119], a[128:131], v[44:47], v[116:119]
    v_mfma_f32_16x16x32_bf16 v[120:123], a[128:131], v[48:51], v[120:123]
    v_mfma_f32_16x16x32_bf16 v[124:127], a[128:131], v[52:55], v[124:127]
    buffer_load_dwordx4 v[36:39], v249, s[48:51], s17 offen sc1
    v_mfma_f32_16x16x32_bf16 v[128:131], a[132:135], v[40:43], v[128:131]
    v_mfma_f32_16x16x32_bf16 v[132:135], a[132:135], v[44:47], v[132:135]
    v_mfma_f32_16x16x32_bf16 v[136:139], a[132:135], v[48:51], v[136:139]
    v_mfma_f32_16x16x32_bf16 v[140:143], a[132:135], v[52:55], v[140:143]
    v_mfma_f32_16x16x32_bf16 v[144:147], a[136:139], v[40:43], v[144:147]
    v_mfma_f32_16x16x32_bf16 v[148:151], a[136:139], v[44:47], v[148:151]
    v_mfma_f32_16x16x32_bf16 v[152:155], a[136:139], v[48:51], v[152:155]
    v_mfma_f32_16x16x32_bf16 v[156:159], a[136:139], v[52:55], v[156:159]
    v_mfma_f32_16x16x32_bf16 v[160:163], a[140:143], v[40:43], v[160:163]
    v_mfma_f32_16x16x32_bf16 v[164:167], a[140:143], v[44:47], v[164:167]
    v_mfma_f32_16x16x32_bf16 v[168:171], a[140:143], v[48:51], v[168:171]
    v_mfma_f32_16x16x32_bf16 v[172:175], a[140:143], v[52:55], v[172:175]
    s_waitcnt vmcnt(19)
    v_mfma_f32_16x16x32_bf16 v[112:115], a[144:147], v[56:59], v[112:115]
    s_waitcnt vmcnt(13)
    v_sub_f32 v186, 0, v6
    v_mfma_f32_16x16x32_bf16 v[116:119], a[144:147], v[60:63], v[116:119]
    v_lshlrev_b32 v204, 16, v176
    v_and_b32 v208, 0xffff0000, v176
    v_mfma_f32_16x16x32_bf16 v[120:123], a[144:147], v[64:67], v[120:123]
    v_lshlrev_b32 v212, 16, v177
    v_and_b32 v216, 0xffff0000, v177
    v_mfma_f32_16x16x32_bf16 v[124:127], a[144:147], v[68:71], v[124:127]
    v_lshlrev_b32 v205, 16, v178
    v_and_b32 v209, 0xffff0000, v178
    v_mfma_f32_16x16x32_bf16 v[128:131], a[148:151], v[56:59], v[128:131]
    v_lshlrev_b32 v213, 16, v179
    v_and_b32 v217, 0xffff0000, v179
    v_mfma_f32_16x16x32_bf16 v[132:135], a[148:151], v[60:63], v[132:135]
    v_lshlrev_b32 v206, 16, v180
    v_and_b32 v210, 0xffff0000, v180
    v_mfma_f32_16x16x32_bf16 v[136:139], a[148:151], v[64:67], v[136:139]
    v_lshlrev_b32 v214, 16, v181
    v_and_b32 v218, 0xffff0000, v181
    v_mfma_f32_16x16x32_bf16 v[140:143], a[148:151], v[68:71], v[140:143]
    v_lshlrev_b32 v207, 16, v182
    v_and_b32 v211, 0xffff0000, v182
    v_mfma_f32_16x16x32_bf16 v[144:147], a[152:155], v[56:59], v[144:147]
    v_lshlrev_b32 v215, 16, v183
    v_and_b32 v219, 0xffff0000, v183
    v_mfma_f32_16x16x32_bf16 v[148:151], a[152:155], v[60:63], v[148:151]
    v_add_f32 v220, v204, v186
    v_add_f32 v221, v205, v186
    v_mfma_f32_16x16x32_bf16 v[152:155], a[152:155], v[64:67], v[152:155]
    v_add_f32 v222, v206, v186
    v_add_f32 v223, v207, v186
    v_mfma_f32_16x16x32_bf16 v[156:159], a[152:155], v[68:71], v[156:159]
    v_add_f32 v224, v208, v186
    v_add_f32 v225, v209, v186
    v_mfma_f32_16x16x32_bf16 v[160:163], a[156:159], v[56:59], v[160:163]
    v_add_f32 v226, v210, v186
    v_add_f32 v227, v211, v186
    v_mfma_f32_16x16x32_bf16 v[164:167], a[156:159], v[60:63], v[164:167]
    v_add_f32 v228, v212, v186
    v_add_f32 v229, v213, v186
    v_mfma_f32_16x16x32_bf16 v[168:171], a[156:159], v[64:67], v[168:171]
    v_add_f32 v230, v214, v186
    v_add_f32 v231, v215, v186
    v_mfma_f32_16x16x32_bf16 v[172:175], a[156:159], v[68:71], v[172:175]
    v_add_f32 v232, v216, v186
    v_add_f32 v233, v217, v186
    s_waitcnt vmcnt(12)
    v_mfma_f32_16x16x32_bf16 v[112:115], a[160:163], v[72:75], v[112:115]
    v_add_f32 v234, v218, v186
    v_add_f32 v235, v219, v186
    v_mfma_f32_16x16x32_bf16 v[116:119], a[160:163], v[76:79], v[116:119]
    v_mul_f32 v220, v220, v7
    v_mul_f32 v221, v221, v7
    v_mfma_f32_16x16x32_bf16 v[120:123], a[160:163], v[80:83], v[120:123]
    v_mul_f32 v222, v222, v7
    v_mul_f32 v223, v223, v7
    v_mfma_f32_16x16x32_bf16 v[124:127], a[160:163], v[84:87], v[124:127]
    v_mul_f32 v224, v224, v7
    v_mul_f32 v225, v225, v7
    v_mfma_f32_16x16x32_bf16 v[128:131], a[164:167], v[72:75], v[128:131]
    v_mul_f32 v226, v226, v7
    v_mul_f32 v227, v227, v7
    v_mfma_f32_16x16x32_bf16 v[132:135], a[164:167], v[76:79], v[132:135]
    v_mul_f32 v228, v228, v7
    v_mul_f32 v229, v229, v7
    v_mfma_f32_16x16x32_bf16 v[136:139], a[164:167], v[80:83], v[136:139]
    v_mul_f32 v230, v230, v7
    v_mul_f32 v231, v231, v7
    v_mfma_f32_16x16x32_bf16 v[140:143], a[164:167], v[84:87], v[140:143]
    v_mul_f32 v232, v232, v7
    v_mul_f32 v233, v233, v7
    v_mfma_f32_16x16x32_bf16 v[144:147], a[168:171], v[72:75], v[144:147]
    v_mul_f32 v234, v234, v7
    v_mul_f32 v235, v235, v7
    v_mfma_f32_16x16x32_bf16 v[148:151], a[168:171], v[76:79], v[148:151]
    v_mfma_f32_16x16x32_bf16 v[152:155], a[168:171], v[80:83], v[152:155]
    v_mfma_f32_16x16x32_bf16 v[156:159], a[168:171], v[84:87], v[156:159]
    v_mfma_f32_16x16x32_bf16 v[160:163], a[172:175], v[72:75], v[160:163]
    v_mfma_f32_16x16x32_bf16 v[164:167], a[172:175], v[76:79], v[164:167]
    v_mfma_f32_16x16x32_bf16 v[168:171], a[172:175], v[80:83], v[168:171]
    v_mfma_f32_16x16x32_bf16 v[172:175], a[172:175], v[84:87], v[172:175]
    s_waitcnt vmcnt(8)
    v_mfma_f32_16x16x32_bf16 v[112:115], a[176:179], v[88:91], v[112:115]
    v_mfma_f32_16x16x32_bf16 v[116:119], a[176:179], v[92:95], v[116:119]
    v_mfma_f32_16x16x32_bf16 v[120:123], a[176:179], v[96:99], v[120:123]
    s_lshl_b32 s75, s89, 7
    s_add_u32 s75, s75, 14683136
    v_mov_b32 v110, s75
    s_cmp_eq_u32 s68, 0
    s_cselect_b64 exec, 1, 0
    global_load_dword v111, v110, s[26:27] sc1
    s_mov_b64 exec, -1
    v_mfma_f32_16x16x32_bf16 v[124:127], a[176:179], v[100:103], v[124:127]
    v_mfma_f32_16x16x32_bf16 v[128:131], a[180:183], v[88:91], v[128:131]
    v_mfma_f32_16x16x32_bf16 v[132:135], a[180:183], v[92:95], v[132:135]
    v_mfma_f32_16x16x32_bf16 v[136:139], a[180:183], v[96:99], v[136:139]
    v_mfma_f32_16x16x32_bf16 v[140:143], a[180:183], v[100:103], v[140:143]
    v_mfma_f32_16x16x32_bf16 v[144:147], a[184:187], v[88:91], v[144:147]
    v_mfma_f32_16x16x32_bf16 v[148:151], a[184:187], v[92:95], v[148:151]
    v_mfma_f32_16x16x32_bf16 v[152:155], a[184:187], v[96:99], v[152:155]
    v_mfma_f32_16x16x32_bf16 v[156:159], a[184:187], v[100:103], v[156:159]
    v_mfma_f32_16x16x32_bf16 v[160:163], a[188:191], v[88:91], v[160:163]
    v_mfma_f32_16x16x32_bf16 v[164:167], a[188:191], v[92:95], v[164:167]
    v_mfma_f32_16x16x32_bf16 v[168:171], a[188:191], v[96:99], v[168:171]
    v_mfma_f32_16x16x32_bf16 v[172:175], a[188:191], v[100:103], v[172:175]
    s_waitcnt vmcnt(5)
    v_mfma_f32_16x16x32_bf16 v[112:115], a[192:195], v[8:11], v[112:115]
    v_mfma_f32_16x16x32_bf16 v[116:119], a[192:195], v[12:15], v[116:119]
    v_mfma_f32_16x16x32_bf16 v[120:123], a[192:195], v[16:19], v[120:123]
    v_mfma_f32_16x16x32_bf16 v[124:127], a[192:195], v[20:23], v[124:127]
    v_mfma_f32_16x16x32_bf16 v[128:131], a[196:199], v[8:11], v[128:131]
    v_mfma_f32_16x16x32_bf16 v[132:135], a[196:199], v[12:15], v[132:135]
    v_mfma_f32_16x16x32_bf16 v[136:139], a[196:199], v[16:19], v[136:139]
    v_mfma_f32_16x16x32_bf16 v[140:143], a[196:199], v[20:23], v[140:143]
    v_mfma_f32_16x16x32_bf16 v[144:147], a[200:203], v[8:11], v[144:147]
    v_mfma_f32_16x16x32_bf16 v[148:151], a[200:203], v[12:15], v[148:151]
    v_mfma_f32_16x16x32_bf16 v[152:155], a[200:203], v[16:19], v[152:155]
    v_mfma_f32_16x16x32_bf16 v[156:159], a[200:203], v[20:23], v[156:159]
    v_mfma_f32_16x16x32_bf16 v[160:163], a[204:207], v[8:11], v[160:163]
    v_mfma_f32_16x16x32_bf16 v[164:167], a[204:207], v[12:15], v[164:167]
    v_mfma_f32_16x16x32_bf16 v[168:171], a[204:207], v[16:19], v[168:171]
    v_mfma_f32_16x16x32_bf16 v[172:175], a[204:207], v[20:23], v[172:175]
    s_waitcnt vmcnt(1)
    v_mfma_f32_16x16x32_bf16 v[112:115], a[208:211], v[24:27], v[112:115]
    v_mfma_f32_16x16x32_bf16 v[116:119], a[208:211], v[28:31], v[116:119]
    v_mfma_f32_16x16x32_bf16 v[120:123], a[208:211], v[32:35], v[120:123]
    v_mfma_f32_16x16x32_bf16 v[124:127], a[208:211], v[36:39], v[124:127]
    v_mfma_f32_16x16x32_bf16 v[128:131], a[212:215], v[24:27], v[128:131]
    v_mfma_f32_16x16x32_bf16 v[132:135], a[212:215], v[28:31], v[132:135]
    v_mfma_f32_16x16x32_bf16 v[136:139], a[212:215], v[32:35], v[136:139]
    v_mfma_f32_16x16x32_bf16 v[140:143], a[212:215], v[36:39], v[140:143]
    v_mfma_f32_16x16x32_bf16 v[144:147], a[216:219], v[24:27], v[144:147]
    v_mfma_f32_16x16x32_bf16 v[148:151], a[216:219], v[28:31], v[148:151]
    v_mfma_f32_16x16x32_bf16 v[152:155], a[216:219], v[32:35], v[152:155]
    v_mfma_f32_16x16x32_bf16 v[156:159], a[216:219], v[36:39], v[156:159]
    v_mfma_f32_16x16x32_bf16 v[160:163], a[220:223], v[24:27], v[160:163]
    v_mfma_f32_16x16x32_bf16 v[164:167], a[220:223], v[28:31], v[164:167]
    v_mfma_f32_16x16x32_bf16 v[168:171], a[220:223], v[32:35], v[168:171]
    v_mfma_f32_16x16x32_bf16 v[172:175], a[220:223], v[36:39], v[172:175]
    s_waitcnt vmcnt(0)
    s_mov_b32 s67, 0
    s_cmp_lg_u32 s68, 0
    s_cbranch_scc1 L_pk_Y
L_pl_Y:
    v_cmp_le_u32 vcc, 32, v111
    s_nop 1
    s_and_b32 s75, vcc_lo, 1
    s_cmp_eq_u32 s75, 1
    s_cbranch_scc1 L_pk_Y
    s_sleep 4
    s_mov_b64 exec, 1
    global_load_dword v111, v110, s[26:27] sc1
    s_mov_b64 exec, -1
    s_waitcnt vmcnt(0)
    s_add_u32 s67, s67, 1
    s_cmp_lt_u32 s67, 0x40000
    s_cbranch_scc1 L_pl_Y
L_pk_Y:
    s_nop 7
    s_barrier
    v_lshrrev_b32 v188, 3, v0
    v_and_b32 v189, 7, v0
    v_lshlrev_b32 v190, 12, v188
    v_lshl_add_u32 v190, v189, 4, v190
    s_lshl_b32 s74, s89, 18
    s_lshl_b32 s75, s88, 7
    s_add_u32 s74, s74, s75
    s_add_u32 s74, s74, 12582912
    s_add_u32 s75, s74, 131072
    buffer_load_dwordx4 v[196:199], v190, s[48:51], s74 offen sc1
    buffer_load_dwordx4 v[200:203], v190, s[48:51], s75 offen sc1
    v_mul_u32_u24 v192, 144, v188
    v_lshl_add_u32 v192, v189, 4, v192
    v_add_u32 v192, 65536, v192
    ds_write_b128 v106, v[116:119] offset:0
    ds_write_b128 v106, v[132:135] offset:1024
    ds_write_b128 v106, v[148:151] offset:2048
    ds_write_b128 v106, v[164:167] offset:3072
    ds_write_b128 v107, v[120:123] offset:0
    ds_write_b128 v107, v[136:139] offset:1024
    ds_write_b128 v107, v[152:155] offset:2048
    ds_write_b128 v107, v[168:171] offset:3072
    ds_write_b128 v108, v[124:127] offset:0
    ds_write_b128 v108, v[140:143] offset:1024
    ds_write_b128 v108, v[156:159] offset:2048
    ds_write_b128 v108, v[172:175] offset:3072
    s_waitcnt vmcnt(0)
    ds_write_b128 v192, v[196:199]
    ds_write_b128 v192, v[200:203] offset:4608
    v_pk_add_f32 v[112:113], v[112:113], v[204:205]
    v_pk_add_f32 v[114:115], v[114:115], v[206:207]
    v_pk_add_f32 v[128:129], v[128:129], v[208:209]
    v_pk_add_f32 v[130:131], v[130:131], v[210:211]
    v_pk_add_f32 v[144:145], v[144:145], v[212:213]
    v_pk_add_f32 v[146:147], v[146:147], v[214:215]
    v_pk_add_f32 v[160:161], v[160:161], v[216:217]
    v_pk_add_f32 v[162:163], v[162:163], v[218:219]
    s_waitcnt lgkmcnt(0)
    s_barrier
    ds_read_b64_tr_b16 v[80:81], v105 offset:0
    ds_read_b64_tr_b16 v[82:83], v105 offset:576
    ds_read_b64_tr_b16 v[84:85], v105 offset:1152
    ds_read_b64_tr_b16 v[86:87], v105 offset:1728
    ds_read_b128 v[32:35], v104 offset:0
    ds_read_b128 v[36:39], v104 offset:1024
    ds_read_b128 v[40:43], v104 offset:2048
    ds_read_b128 v[44:47], v104 offset:3072
    ds_read_b128 v[48:51], v104 offset:4096
    ds_read_b128 v[52:55], v104 offset:5120
    ds_read_b128 v[56:59], v104 offset:6144
    ds_read_b128 v[60:63], v104 offset:7168
    ds_read_b128 v[64:67], v104 offset:8192
    ds_read_b128 v[68:71], v104 offset:9216
    ds_read_b128 v[72:75], v104 offset:10240
    ds_read_b128 v[76:79], v104 offset:11264
    s_waitcnt lgkmcnt(12)
    v_lshlrev_b32 v8, 16, v80
    v_and_b32 v12, 0xffff0000, v80
    v_lshlrev_b32 v16, 16, v81
    v_and_b32 v20, 0xffff0000, v81
    v_lshlrev_b32 v9, 16, v82
    v_and_b32 v13, 0xffff0000, v82
    v_lshlrev_b32 v17, 16, v83
    v_and_b32 v21, 0xffff0000, v83
    v_lshlrev_b32 v10, 16, v84
    v_and_b32 v14, 0xffff0000, v84
    v_lshlrev_b32 v18, 16, v85
    v_and_b32 v22, 0xffff0000, v85
    v_lshlrev_b32 v11, 16, v86
    v_and_b32 v15, 0xffff0000, v86
    v_lshlrev_b32 v19, 16, v87
    v_and_b32 v23, 0xffff0000, v87
    v_pk_fma_f32 v[112:113], v[220:221], v[8:9], v[112:113]
    v_pk_fma_f32 v[114:115], v[222:223], v[10:11], v[114:115]
    v_pk_fma_f32 v[128:129], v[224:225], v[12:13], v[128:129]
    v_pk_fma_f32 v[130:131], v[226:227], v[14:15], v[130:131]
    v_pk_fma_f32 v[144:145], v[228:229], v[16:17], v[144:145]
    v_pk_fma_f32 v[146:147], v[230:231], v[18:19], v[146:147]
    v_pk_fma_f32 v[160:161], v[232:233], v[20:21], v[160:161]
    v_pk_fma_f32 v[162:163], v[234:235], v[22:23], v[162:163]
    s_waitcnt lgkmcnt(8)
    v_pk_add_f32 v[112:113], v[112:113], v[32:33]
    v_pk_add_f32 v[114:115], v[114:115], v[34:35]
    v_pk_add_f32 v[128:129], v[128:129], v[36:37]
    v_pk_add_f32 v[130:131], v[130:131], v[38:39]
    v_pk_add_f32 v[144:145], v[144:145], v[40:41]
    v_pk_add_f32 v[146:147], v[146:147], v[42:43]
    v_pk_add_f32 v[160:161], v[160:161], v[44:45]
    v_pk_add_f32 v[162:163], v[162:163], v[46:47]
    s_waitcnt lgkmcnt(4)
    v_pk_add_f32 v[112:113], v[112:113], v[48:49]
    v_pk_add_f32 v[114:115], v[114:115], v[50:51]
    v_pk_add_f32 v[128:129], v[128:129], v[52:53]
    v_pk_add_f32 v[130:131], v[130:131], v[54:55]
    v_pk_add_f32 v[144:145], v[144:145], v[56:57]
    v_pk_add_f32 v[146:147], v[146:147], v[58:59]
    v_pk_add_f32 v[160:161], v[160:161], v[60:61]
    v_pk_add_f32 v[162:163], v[162:163], v[62:63]
    s_waitcnt lgkmcnt(0)
    v_pk_add_f32 v[112:113], v[112:113], v[64:65]
    v_pk_add_f32 v[114:115], v[114:115], v[66:67]
    v_pk_add_f32 v[128:129], v[128:129], v[68:69]
    v_pk_add_f32 v[130:131], v[130:131], v[70:71]
    v_pk_add_f32 v[144:145], v[144:145], v[72:73]
    v_pk_add_f32 v[146:147], v[146:147], v[74:75]
    v_pk_add_f32 v[160:161], v[160:161], v[76:77]
    v_pk_add_f32 v[162:163], v[162:163], v[78:79]
    v_cvt_pk_bf16_f32 v24, v112, v128
    v_cvt_pk_bf16_f32 v25, v144, v160
    v_cvt_pk_bf16_f32 v26, v113, v129
    v_cvt_pk_bf16_f32 v27, v145, v161
    v_cvt_pk_bf16_f32 v28, v114, v130
    v_cvt_pk_bf16_f32 v29, v146, v162
    v_cvt_pk_bf16_f32 v30, v115, v131
    v_cvt_pk_bf16_f32 v31, v147, v163
    buffer_store_dwordx4 v[24:27], v184, s[60:63], 0 offen
    buffer_store_dwordx4 v[28:31], v184, s[60:63], 0 offen offset:16
L_end:
    s_endpgm
.section .rodata,"a"
.p2align 6
.amdhsa_kernel parallel_sum__ssm_conv_h3__dense_activation_silu__prompt_kernel
  .amdhsa_next_free_vgpr 512
  .amdhsa_next_free_sgpr 102
  .amdhsa_accum_offset 256
  .amdhsa_group_segment_fixed_size 0
  .amdhsa_kernarg_size 96
  .amdhsa_user_sgpr_count 2
  .amdhsa_user_sgpr_kernarg_segment_ptr 1
  .amdhsa_system_sgpr_workgroup_id_x 1
  .amdhsa_float_denorm_mode_32 3
.end_amdhsa_kernel
```
